```python
import torch

def _softmax(x, axis=-1):
    return torch.softmax(x, dim=axis)
def _gelu(x):
    return torch.nn.functional.gelu(x, approximate="tanh")
def _silu(x):
    return torch.nn.functional.silu(x)
def _sigmoid(x):
    return torch.sigmoid(x)
def _layernorm(x, axis=-1, eps=1e-5):
    m = x.mean(dim=axis, keepdim=True)
    v = x.var(dim=axis, keepdim=True, unbiased=False)
    return (x - m) / torch.sqrt(v + eps)
def _scatter_add(tgt, idx, src, axis=0):
    return tgt.clone().index_add_(axis, idx, src)
def _segment_sum(src, seg, n):
    out = torch.zeros((n,) + src.shape[1:], dtype=src.dtype)
    return out.index_add_(0, seg, src)
def _pad(x, pw):
    flat = tuple(v for pair in reversed(pw) for v in pair)
    return torch.nn.functional.pad(x, flat)

kernel_name = 'gated_mix__ssm_conv_s4__glu_gated_glu__prompt'

def setup_inputs():

    _w = (lambda a: (lambda t: t.to(torch.bfloat16) if t.is_floating_point() else t)(torch.as_tensor(a)))
    def _A_setup():
        B, L, D, N = 1, 2048, 512, 128
        A_re = -(lambda _x: torch.exp(torch.as_tensor(_x)))((lambda *s: torch.randn(*s, dtype=torch.bfloat16) * 6.4)(D, N))
        A_im = torch.pi * (lambda *s: torch.randn(*s, dtype=torch.bfloat16) * 0.1)(D, N)
        B_re = (lambda *s: torch.randn(*s, dtype=torch.bfloat16) * 0.2)(D, N)
        B_im = (lambda *s: torch.randn(*s, dtype=torch.bfloat16) * 0.2)(D, N)
        C_re = (lambda *s: torch.randn(*s, dtype=torch.bfloat16) * 0.2)(D, N)
        C_im = (lambda *s: torch.randn(*s, dtype=torch.bfloat16) * 0.2)(D, N)
        log_dt = (lambda *s: torch.randn(*s, dtype=torch.bfloat16) * 0.1)(D) * 0.5 - 4.0
        Dskip = (lambda *s: torch.randn(*s, dtype=torch.bfloat16) * 0.1)(D)
        return {
            "u": _w((lambda *s: torch.randn(*s, dtype=torch.bfloat16) * 0.05)(B, L, D)),
            "A_re": _w(A_re),
            "A_im": _w(A_im),
            "B_re": _w(B_re),
            "B_im": _w(B_im),
            "C_re": _w(C_re),
            "C_im": _w(C_im),
            "log_dt": _w(log_dt),
            "Dskip": _w(Dskip),
        }
    _A_in = _A_setup()

    def _B_setup():
        B, S, D, F = 1, 2048, 512, 1792
        return {
            "x": _w((lambda *s: torch.randn(*s, dtype=torch.bfloat16) * 0.05)(B, S, D)),
            "w_gate": _w((lambda *s: torch.randn(*s, dtype=torch.bfloat16) * 0.4)(D, F)),
            "w_up": _w((lambda *s: torch.randn(*s, dtype=torch.bfloat16) * 0.05)(D, F)),
            "w_down": _w((lambda *s: torch.randn(*s, dtype=torch.bfloat16) * 0.05)(F, D)),
        }
    _B_in = _B_setup()

    return {
        "A_u": _A_in["u"],
        "A_A_re": _A_in["A_re"],
        "A_A_im": _A_in["A_im"],
        "A_B_re": _A_in["B_re"],
        "A_B_im": _A_in["B_im"],
        "A_C_re": _A_in["C_re"],
        "A_C_im": _A_in["C_im"],
        "A_log_dt": _A_in["log_dt"],
        "A_Dskip": _A_in["Dskip"],
        "B_x": _B_in["x"],
        "B_w_gate": _B_in["w_gate"],
        "B_w_up": _B_in["w_up"],
        "B_w_down": _B_in["w_down"],
        "gate_w": _w((lambda *s: torch.randn(*s, dtype=torch.bfloat16) * 0.05)(512) * 16.0),
    }

def reference(A_u, A_A_re, A_A_im, A_B_re, A_B_im, A_C_re, A_C_im, A_log_dt, A_Dskip, B_x, B_w_gate, B_w_up, B_w_down, gate_w):
    def _A_ref(u, A_re, A_im, B_re, B_im, C_re, C_im, log_dt, Dskip):
        Bsz, L, D = u.shape
        dt = torch.exp(log_dt)[:, None]
        A = A_re + 1j * A_im
        Bc = B_re + 1j * B_im
        Cc = C_re + 1j * C_im
        logdA = dt * A
        dB = dt * Bc
        l = (lambda x, dt: x.to(dt))(torch.arange(L), A_re.dtype)
        P = torch.exp(logdA[:, :, None] * l[None, None, :])
        K = torch.einsum("dn,dnl,dn->dl", Cc, P, dB).real
        L2 = 2 * L
        Kp = _pad(K, ((0, 0), (0, L)))
        up = (lambda x, *d: x.permute(*d))(u, 0, 2, 1)
        up = _pad(up, ((0, 0), (0, 0), (0, L)))
        Kf = (lambda x, axes=(-2,-1): torch.fft.rfft2(x.float(), dim=axes))(Kp[:, None, :], axes=(-2, -1))
        Uf = (lambda x, axes=(-2,-1): torch.fft.rfft2(x.float(), dim=axes))(up[:, :, None, :], axes=(-2, -1))
        Yf = Uf * Kf[None, :, :, :]
        y = (lambda x, s, axes=(-2,-1): torch.fft.irfft2(x, s=s, dim=axes).to(torch.bfloat16))(Yf, (1, L2), axes=(-2, -1))[:, :, 0, :L]
        y = (lambda x, *d: x.permute(*d))(y, 0, 2, 1) + u * Dskip[None, None, :]
        return y

    def _B_ref(x, w_gate, w_up, w_down):
        g = torch.einsum("bsd,df->bsf", x, w_gate)
        u = torch.einsum("bsd,df->bsf", x, w_up)
        h = _sigmoid(g) * u
        return torch.einsum("bsf,fd->bsd", h, w_down)

    x = A_u
    g = _sigmoid((x * gate_w).sum(-1, keepdims=True))
    a = _A_ref(x, A_A_re, A_A_im, A_B_re, A_B_im, A_C_re, A_C_im, A_log_dt, A_Dskip)
    b = _B_ref(x, B_w_gate, B_w_up, B_w_down)
    return g * a + (1 - g) * b
```

```asm
; @launch grid=(256,1,1) block=(512,1,1) lds=163840
.amdgcn_target "amdgcn-amd-amdhsa--gfx950"
.text
.globl gated_mix__ssm_conv_s4__glu_gated_glu__prompt_kernel
.p2align 8
.type gated_mix__ssm_conv_s4__glu_gated_glu__prompt_kernel,@function
gated_mix__ssm_conv_s4__glu_gated_glu__prompt_kernel:
  s_cmp_ge_u32 s2, 256
  s_cbranch_scc1 K_END
  s_cmp_ge_u32 s2, 32
  s_cbranch_scc1 K_NPF
  s_getpc_b64 s[4:5]
  v_lshlrev_b32 v2, 7, v0
  v_min_u32 v2, K_END-K_NPF, v2
  global_load_dword v255, v2, s[4:5]
K_NPF:
  s_load_dwordx16 s[32:47], s[0:1], 0
  s_load_dwordx16 s[48:63], s[0:1], 64
  s_load_dwordx2 s[64:65], s[0:1], 128
  v_and_b32 v1, 63, v0
  v_lshrrev_b32 v2, 6, v0
  s_nop 0
  v_readfirstlane_b32 s3, v2
  s_and_b32 s24, s2, 7
  s_lshr_b32 s25, s2, 3
  s_lshl_b32 s67, s24, 2
  s_lshr_b32 s68, s25, 3
  s_add_u32 s67, s67, s68
  s_and_b32 s68, s25, 7
  s_add_u32 s25, s25, 28
  s_and_b32 s25, s25, 31
  s_lshr_b32 s26, s24, 1
  s_lshl_b32 s26, s26, 2
  s_and_b32 s29, s25, 3
  s_add_u32 s26, s26, s29
  s_and_b32 s27, s24, 1
  s_mul_i32 s27, s27, 7
  s_lshr_b32 s30, s25, 2
  s_add_u32 s27, s27, s30
  s_and_b32 s28, s24, 6
  s_cmp_lt_u32 s3, 4
  s_cbranch_scc0 K_HELP
  s_cmp_ge_u32 s25, 28
  s_cbranch_scc1 K_MAIN
  s_and_b32 s71, s3, 1
  s_lshr_b32 s69, s3, 1
  s_lshl_b32 s70, s2, 1
  s_add_u32 s70, s70, s69
  s_lshl_b32 s73, s70, 8
  s_lshl_b32 s74, s71, 7
  s_add_u32 s73, s73, s74
  v_lshl_add_u32 v2, v1, 1, s73
  s_lshl_b32 s73, s70, 1
  v_mov_b32 v3, s73
  s_waitcnt lgkmcnt(0)
  global_load_ushort v186, v3, s[46:47]
  global_load_ushort v180, v2, s[34:35]
  global_load_ushort v181, v2, s[36:37]
  global_load_ushort v182, v2, s[38:39]
  global_load_ushort v183, v2, s[40:41]
  global_load_ushort v184, v2, s[42:43]
  global_load_ushort v185, v2, s[44:45]
  s_branch K_MAIN
K_HELP:
  s_sub_u32 s3, s3, 4
  s_and_b32 s71, s3, 1
  s_lshr_b32 s69, s3, 1
  s_lshl_b32 s70, s2, 1
  s_add_u32 s70, s70, s69
  v_lshrrev_b32 v4, 4, v1
  v_and_b32 v5, 15, v1
  v_lshlrev_b32 v6, 2, v4
  v_xor_b32 v5, v5, v6
  s_lshl_b32 s75, s71, 1
  v_xor_b32 v5, s75, v5
  v_mul_u32_u24 v6, 3584, v4
  v_lshl_add_u32 v60, v5, 4, v6
  s_lshl_b32 s75, s71, 2
  v_add_u32 v4, s75, v4
  v_and_b32 v5, 7, v1
  v_xor_b32 v5, v5, v4
  v_lshrrev_b32 v6, 3, v1
  v_lshlrev_b32 v6, 10, v6
  v_lshl_add_u32 v62, v5, 4, v6
  s_mul_i32 s66, s3, 28672
  s_lshl_b32 s78, s27, 8
  s_add_u32 s66, s66, s78
  s_lshl_b32 s77, s26, 17
  s_lshl_b32 s78, s3, 13
  s_add_u32 s77, s77, s78
  s_lshl_b32 s79, s3, 11
  s_lshl_b32 s80, s3, 10
  s_cmp_ge_u32 s25, 28
  s_cselect_b32 s81, 1, 0
  s_lshl_b32 s73, s70, 8
  s_lshl_b32 s74, s71, 7
  s_add_u32 s73, s73, s74
  v_lshl_add_u32 v2, v1, 1, s73
  s_lshl_b32 s73, s70, 1
  v_mov_b32 v3, s73
  s_waitcnt lgkmcnt(0)
  s_mov_b32 s4, s32
  s_mov_b32 s5, s33
  s_mov_b32 s6, 0x200000
  s_mov_b32 s7, 0x20000
  s_mov_b32 s8, s52
  s_mov_b32 s9, s53
  s_mov_b32 s10, 0x1c0000
  s_mov_b32 s11, 0x20000
  s_mov_b32 s12, s54
  s_mov_b32 s13, s55
  s_mov_b32 s14, 0x1c0000
  s_mov_b32 s15, 0x20000
  s_cmp_eq_u32 s81, 1
  s_cbranch_scc1 H_PREP
  s_add_u32 s82, s28, 0
  s_and_b32 s82, s82, 7
  s_lshl_b32 s82, s82, 7
  s_add_u32 s82, s82, s77
  s_add_u32 m0, s80, 65536
  s_nop 0
  buffer_load_dwordx4 v62, s[4:7], s82 offen lds
  s_add_u32 s82, s82, 32768
  s_add_u32 m0, s80, 69632
  s_nop 0
  buffer_load_dwordx4 v62, s[4:7], s82 offen lds
  s_add_u32 s82, s82, 32768
  s_add_u32 m0, s80, 73728
  s_nop 0
  buffer_load_dwordx4 v62, s[4:7], s82 offen lds
  s_add_u32 s82, s82, 32768
  s_add_u32 m0, s80, 77824
  s_nop 0
  buffer_load_dwordx4 v62, s[4:7], s82 offen lds
  s_add_u32 s82, s28, 0
  s_and_b32 s82, s82, 7
  s_mul_i32 s82, s82, 229376
  s_add_u32 s82, s82, s66
  s_add_u32 s83, s82, 14336
  s_add_u32 m0, s79, 0
  s_nop 0
  buffer_load_dwordx4 v60, s[8:11], s82 offen lds
  s_add_u32 m0, s79, 1024
  s_nop 0
  buffer_load_dwordx4 v60, s[8:11], s83 offen lds
  s_add_u32 m0, s79, 8192
  s_nop 0
  buffer_load_dwordx4 v60, s[12:15], s82 offen lds
  s_add_u32 m0, s79, 9216
  s_nop 0
  buffer_load_dwordx4 v60, s[12:15], s83 offen lds
  global_load_ushort v17, v3, s[48:49]
  s_add_u32 s82, s28, 0
  s_and_b32 s82, s82, 7
  s_mul_i32 s82, s82, 229376
  s_add_u32 s82, s82, s66
  s_add_u32 s82, s82, 114688
  s_add_u32 s83, s82, 14336
  s_add_u32 m0, s79, 16384
  s_nop 0
  buffer_load_dwordx4 v60, s[8:11], s82 offen lds
  s_mov_b32 s16, s64
  s_mov_b32 s17, s65
  s_mov_b32 s18, 0x1000000
  s_mov_b32 s19, 0x20000
  s_cmp_eq_u32 s69, 0
  s_mov_b32 s72, 98304
  s_cselect_b32 s72, 131072, s72
  s_add_u32 s75, s72, 2560
  s_add_u32 s78, s72, 31232
  s_lshl_b32 s73, s3, 2
  s_add_u32 s73, s73, 163824
  v_mov_b32 v221, s73
  v_xor_b32 v222, 4, v221
  v_mov_b32 v7, 0
  ds_write_b32 v221, v7
  v_subrev_u32 v4, 16, v221
  ds_write_b32 v4, v7
  s_add_u32 m0, s79, 17408
  s_nop 0
  buffer_load_dwordx4 v60, s[8:11], s83 offen lds
  v_mov_b32 v212, 163792
  ds_write_b32 v212, v7
  ds_write_b32 v212, v7 offset:4
  ds_write_b32 v212, v7 offset:8
  v_mov_b32 v213, 163796
  v_mov_b32 v214, 0
  v_subrev_u32 v217, 48, v221
  ds_write_b32 v217, v7
  v_subrev_u32 v223, 64, v221
  ds_write_b32 v223, v7
  v_bfe_u32 v4, v1, 4, 1
  v_lshlrev_b32 v219, 2, v4
  v_and_b32 v5, 7, v1
  v_xor_b32 v219, v219, v5
  s_add_u32 m0, s79, 24576
  s_nop 0
  buffer_load_dwordx4 v60, s[12:15], s82 offen lds
  v_lshlrev_b32 v219, 4, v219
  v_lshrrev_b32 v5, 3, v1
  v_lshl_add_u32 v219, v5, 10, v219
  v_xor_b32 v218, 32, v219
  s_mul_i32 s29, s3, 458752
  s_lshl_b32 s30, s68, 7
  s_add_u32 s29, s29, s30
  s_mul_i32 s30, s3, 4096
  s_add_u32 s30, s30, 131072
  s_mov_b32 s24, s56
  s_mov_b32 s25, s57
  s_mov_b32 s26, 0x1c0000
  s_mov_b32 s27, 0x20000
  s_mul_i32 s78, s69, 1344
  s_add_u32 s78, s78, 161024
  s_add_u32 m0, s79, 25600
  s_nop 0
  buffer_load_dwordx4 v60, s[12:15], s83 offen lds
  s_mov_b32 s75, s72
  v_and_b32 v2, 15, v1
  v_lshrrev_b32 v3, 4, v1
  v_lshrrev_b32 v4, 2, v1
  v_mul_u32_u24 v4, 112, v4
  v_and_b32 v5, 3, v1
  v_lshl_add_u32 v4, v5, 3, v4
  v_add_u32 v206, s75, v4
  s_lshl_b32 s73, s71, 5
  s_add_u32 s73, s73, 48
  v_add_u32 v207, s73, v206
  v_mov_b32 v49, 0
  v_mov_b32 v50, 0
  v_mov_b32 v51, 0
  s_add_u32 s82, s28, 1
  s_and_b32 s82, s82, 7
  s_lshl_b32 s82, s82, 7
  s_add_u32 s82, s82, s77
  s_add_u32 m0, s80, 81920
  s_nop 0
  buffer_load_dwordx4 v62, s[4:7], s82 offen lds
  v_mov_b32 v52, 0
  v_mov_b32 v53, 0
  v_mov_b32 v54, 0
  v_mov_b32 v55, 0
  v_lshl_add_u32 v6, s71, 4, v2
  v_lshlrev_b32 v7, 3, v6
  v_lshl_add_u32 v7, v3, 2, v7
  v_lshlrev_b32 v8, 2, v6
  v_add_u32 v8, 256, v8
  v_cmp_eq_u32 s[20:21], 2, v3
  s_nop 1
  v_cndmask_b32 v7, v7, v8, s[20:21]
  v_lshlrev_b32 v8, 1, v6
  v_add_u32 v8, 384, v8
  v_cmp_eq_u32 s[20:21], 3, v3
  s_nop 1
  v_cndmask_b32 v7, v7, v8, s[20:21]
  s_add_u32 s82, s82, 32768
  s_add_u32 m0, s80, 86016
  s_nop 0
  buffer_load_dwordx4 v62, s[4:7], s82 offen lds
  v_cndmask_b32 v8, 2, 64, s[20:21]
  v_add_u32 v8, v7, v8
  v_lshl_add_u32 v208, v7, 1, s78
  v_lshl_add_u32 v209, v8, 1, s78
  v_lshl_add_u32 v9, v3, 7, v6
  v_lshl_add_u32 v210, v9, 1, s78
  v_lshl_add_u32 v6, s71, 6, v1
  v_mul_u32_u24 v211, 112, v6
  v_add_u32 v211, s75, v211
  v_cmp_eq_u32 s[22:23], 0, v6
  v_lshlrev_b32 v203, 4, v1
  s_mul_i32 s73, s71, 6272
  s_add_u32 s73, s73, s72
  v_min_u32 v4, 55, v1
  s_add_u32 s82, s82, 32768
  s_add_u32 m0, s80, 90112
  s_nop 0
  buffer_load_dwordx4 v62, s[4:7], s82 offen lds
  v_lshrrev_b32 v192, 3, v4
  v_lshl_add_u32 v192, v192, 1, v4
  v_lshl_add_u32 v192, v192, 4, s73
  s_mul_i32 s73, s71, 8832
  s_add_u32 s73, s73, s72
  v_min_u32 v193, 6, v1
  v_lshl_add_u32 v193, v193, 4, s73
  v_mov_b32 v194, s72
  s_lshl_b32 s73, s71, 7
  v_add_u32 v4, s73, v1
  v_lshrrev_b32 v195, 3, v4
  v_lshl_add_u32 v195, v195, 1, v4
  v_lshl_add_u32 v195, v195, 4, s72
  v_add_u32 v4, 1, v4
  v_lshrrev_b32 v196, 3, v4
  s_add_u32 s82, s82, 32768
  s_add_u32 m0, s80, 94208
  s_nop 0
  buffer_load_dwordx4 v62, s[4:7], s82 offen lds
  v_lshl_add_u32 v196, v196, 1, v4
  v_lshl_add_u32 v196, v196, 4, s72
  s_lshl_b32 s73, s71, 11
  s_add_u32 s73, s73, s72
  v_add_u32 v197, s73, v203
  v_and_b32 v4, 3, v1
  v_mul_u32_u24 v4, 4416, v4
  v_bfe_u32 v5, v1, 2, 2
  v_lshrrev_b32 v6, 4, v1
  v_sub_u32 v5, v5, v6
  v_lshl_add_u32 v4, v5, 4, v4
  s_lshl_b32 s73, s71, 9
  s_add_u32 s73, s73, s72
  s_add_u32 s73, s73, 48
  s_add_u32 s82, s28, 1
  s_and_b32 s82, s82, 7
  s_mul_i32 s82, s82, 229376
  s_add_u32 s82, s82, s66
  s_add_u32 s83, s82, 14336
  s_add_u32 m0, s79, 32768
  s_nop 0
  buffer_load_dwordx4 v60, s[8:11], s82 offen lds
  v_add_u32 v201, s73, v4
  v_and_b32 v4, 1, v1
  v_mul_u32_u24 v7, 6272, v4
  v_bfe_u32 v5, v1, 1, 3
  v_mul_u32_u24 v8, 160, v5
  v_add_u32 v7, v7, v8
  v_lshl_add_u32 v7, v6, 4, v7
  s_mul_i32 s73, s71, 640
  s_sub_u32 s73, s72, s73
  s_add_u32 s73, s73, 18304
  v_add_u32 v202, s73, v7
  v_lshlrev_b32 v5, 7, v5
  v_lshl_add_u32 v5, v4, 3, v5
  v_lshl_add_u32 v5, v6, 4, v5
  s_mul_i32 s73, s71, 12288
  s_add_u32 m0, s79, 33792
  s_nop 0
  buffer_load_dwordx4 v60, s[8:11], s83 offen lds
  s_add_u32 s73, s73, s72
  v_add_u32 v198, s73, v5
  v_add_u32 v220, s73, v203
  s_lshl_b32 s73, s3, 12
  s_add_u32 s73, s73, 81920
  v_add_u32 v199, s73, v203
  v_xor_b32 v200, 0x1000, v199
  s_lshl_b32 s73, s71, 10
  v_lshl_add_u32 v46, v1, 3, s73
  v_lshl_add_u32 v47, v46, 1, s78
  v_cvt_f32_u32 v46, v46
  s_sub_u32 s74, s78, 34048
  s_add_u32 s73, s78, 256
  v_mov_b32 v57, s73
  v_add_f32 v224, 0xc0400000, v46
  s_add_u32 m0, s79, 40960
  s_nop 0
  buffer_load_dwordx4 v60, s[12:15], s82 offen lds
  v_cvt_pk_bf16_f32 v224, v224, 0
  v_lshl_add_u32 v224, v224, 1, s74
  v_add_u32 v56, -6, v47
  v_med3_i32 v224, v224, v56, v57
  v_add_f32 v225, 0xc0000000, v46
  v_cvt_pk_bf16_f32 v225, v225, 0
  v_lshl_add_u32 v225, v225, 1, s74
  v_add_u32 v56, -4, v47
  v_med3_i32 v225, v225, v56, v57
  v_add_f32 v226, 0xbf800000, v46
  v_cvt_pk_bf16_f32 v226, v226, 0
  v_lshl_add_u32 v226, v226, 1, s74
  v_add_u32 v56, -2, v47
  v_med3_i32 v226, v226, v56, v57
  s_add_u32 m0, s79, 41984
  s_nop 0
  buffer_load_dwordx4 v60, s[12:15], s83 offen lds
  v_add_f32 v227, 0x0, v46
  v_cvt_pk_bf16_f32 v227, v227, 0
  v_lshl_add_u32 v227, v227, 1, s74
  v_add_u32 v56, 0, v47
  v_med3_i32 v227, v227, v56, v57
  v_add_f32 v228, 0x3f800000, v46
  v_cvt_pk_bf16_f32 v228, v228, 0
  v_lshl_add_u32 v228, v228, 1, s74
  v_add_u32 v56, 2, v47
  v_med3_i32 v228, v228, v56, v57
  v_add_f32 v229, 0x40000000, v46
  v_cvt_pk_bf16_f32 v229, v229, 0
  v_lshl_add_u32 v229, v229, 1, s74
  v_add_u32 v56, 4, v47
  v_med3_i32 v229, v229, v56, v57
  s_add_u32 s82, s28, 1
  s_and_b32 s82, s82, 7
  s_mul_i32 s82, s82, 229376
  s_add_u32 s82, s82, s66
  s_add_u32 s82, s82, 114688
  s_add_u32 s83, s82, 14336
  s_add_u32 m0, s79, 49152
  s_nop 0
  buffer_load_dwordx4 v60, s[8:11], s82 offen lds
  v_add_f32 v230, 0x40400000, v46
  v_cvt_pk_bf16_f32 v230, v230, 0
  v_lshl_add_u32 v230, v230, 1, s74
  v_add_u32 v56, 6, v47
  v_med3_i32 v230, v230, v56, v57
  v_add_f32 v231, 0x40800000, v46
  v_cvt_pk_bf16_f32 v231, v231, 0
  v_lshl_add_u32 v231, v231, 1, s74
  v_add_u32 v56, 8, v47
  v_med3_i32 v231, v231, v56, v57
  v_add_f32 v232, 0x40a00000, v46
  v_cvt_pk_bf16_f32 v232, v232, 0
  v_lshl_add_u32 v232, v232, 1, s74
  v_add_u32 v56, 10, v47
  s_add_u32 m0, s79, 50176
  s_nop 0
  buffer_load_dwordx4 v60, s[8:11], s83 offen lds
  v_med3_i32 v232, v232, v56, v57
  v_add_f32 v233, 0x40c00000, v46
  v_cvt_pk_bf16_f32 v233, v233, 0
  v_lshl_add_u32 v233, v233, 1, s74
  v_add_u32 v56, 12, v47
  v_med3_i32 v233, v233, v56, v57
  v_add_f32 v234, 0x40e00000, v46
  v_cvt_pk_bf16_f32 v234, v234, 0
  v_lshl_add_u32 v234, v234, 1, s74
  v_add_u32 v56, 14, v47
  v_med3_i32 v234, v234, v56, v57
  v_add_f32 v235, 0x43fe8000, v46
  v_cvt_pk_bf16_f32 v235, v235, 0
  v_lshl_add_u32 v235, v235, 1, s74
  v_add_f32 v236, 0x43ff0000, v46
  s_add_u32 m0, s79, 57344
  s_nop 0
  buffer_load_dwordx4 v60, s[12:15], s82 offen lds
  v_cvt_pk_bf16_f32 v236, v236, 0
  v_lshl_add_u32 v236, v236, 1, s74
  v_add_f32 v237, 0x43ff8000, v46
  v_cvt_pk_bf16_f32 v237, v237, 0
  v_lshl_add_u32 v237, v237, 1, s74
  v_add_f32 v238, 0x44000000, v46
  v_cvt_pk_bf16_f32 v238, v238, 0
  v_lshl_add_u32 v238, v238, 1, s74
  v_add_f32 v239, 0x44004000, v46
  v_cvt_pk_bf16_f32 v239, v239, 0
  v_lshl_add_u32 v239, v239, 1, s74
  v_add_f32 v240, 0x44008000, v46
  v_cvt_pk_bf16_f32 v240, v240, 0
  v_lshl_add_u32 v240, v240, 1, s74
  s_add_u32 m0, s79, 58368
  s_nop 0
  buffer_load_dwordx4 v60, s[12:15], s83 offen lds
  v_add_f32 v241, 0x4400c000, v46
  v_cvt_pk_bf16_f32 v241, v241, 0
  v_lshl_add_u32 v241, v241, 1, s74
  v_add_f32 v242, 0x44010000, v46
  v_cvt_pk_bf16_f32 v242, v242, 0
  v_lshl_add_u32 v242, v242, 1, s74
  v_add_f32 v243, 0x44014000, v46
  v_cvt_pk_bf16_f32 v243, v243, 0
  v_lshl_add_u32 v243, v243, 1, s74
  v_add_f32 v244, 0x44018000, v46
  v_cvt_pk_bf16_f32 v244, v244, 0
  v_lshl_add_u32 v244, v244, 1, s74
  v_add_f32 v245, 0x4401c000, v46
  v_cvt_pk_bf16_f32 v245, v245, 0
  v_lshl_add_u32 v245, v245, 1, s74
  s_waitcnt lgkmcnt(0)
  s_waitcnt vmcnt(16)
  s_waitcnt vmcnt(12)
  v_lshlrev_b32 v17, 16, v17
  v_cndmask_b32 v48, 0, v17, s[22:23]
  s_barrier
  ds_read_b64_tr_b16 v[64:65], v206 offset:0
  ds_read_b64_tr_b16 v[66:67], v206 offset:14336
  ds_read_b64_tr_b16 v[68:69], v207 offset:0
  ds_read_b64_tr_b16 v[70:71], v207 offset:14336
  ds_read_b64_tr_b16 v[72:73], v206 offset:32
  ds_read_b64_tr_b16 v[74:75], v206 offset:14368
  ds_read_b64_tr_b16 v[76:77], v206 offset:1792
  ds_read_b64_tr_b16 v[78:79], v206 offset:16128
  ds_read_b64_tr_b16 v[80:81], v207 offset:1792
  ds_read_b64_tr_b16 v[82:83], v207 offset:16128
  ds_read_b64_tr_b16 v[84:85], v206 offset:1824
  ds_read_b64_tr_b16 v[86:87], v206 offset:16160
  ds_read_b64_tr_b16 v[88:89], v206 offset:3584
  ds_read_b64_tr_b16 v[90:91], v206 offset:17920
  ds_read_b64_tr_b16 v[92:93], v207 offset:3584
  ds_read_b64_tr_b16 v[94:95], v207 offset:17920
  ds_read_b64_tr_b16 v[96:97], v206 offset:3616
  ds_read_b64_tr_b16 v[98:99], v206 offset:17952
  ds_read_b64_tr_b16 v[100:101], v206 offset:5376
  ds_read_b64_tr_b16 v[102:103], v206 offset:19712
  ds_read_b64_tr_b16 v[104:105], v207 offset:5376
  ds_read_b64_tr_b16 v[106:107], v207 offset:19712
  ds_read_b64_tr_b16 v[108:109], v206 offset:5408
  ds_read_b64_tr_b16 v[110:111], v206 offset:19744
  s_waitcnt vmcnt(12)
  s_barrier
  s_add_u32 s82, s28, 2
  s_and_b32 s82, s82, 7
  s_mul_i32 s82, s82, 229376
  s_add_u32 s82, s82, s66
  s_add_u32 s82, s82, 114688
  s_add_u32 s83, s82, 14336
  s_add_u32 m0, s79, 0
  s_nop 0
  buffer_load_dwordx4 v60, s[8:11], s82 offen lds
  ds_read_b64_tr_b16 v[112:113], v206 offset:7168
  ds_read_b64_tr_b16 v[114:115], v206 offset:21504
  ds_read_b64_tr_b16 v[116:117], v207 offset:7168
  ds_read_b64_tr_b16 v[118:119], v207 offset:21504
  ds_read_b64_tr_b16 v[120:121], v206 offset:7200
  ds_read_b64_tr_b16 v[122:123], v206 offset:21536
  s_add_u32 m0, s79, 1024
  s_nop 0
  buffer_load_dwordx4 v60, s[8:11], s83 offen lds
  ds_read_b64_tr_b16 v[124:125], v206 offset:8960
  ds_read_b64_tr_b16 v[126:127], v206 offset:23296
  ds_read_b64_tr_b16 v[128:129], v207 offset:8960
  ds_read_b64_tr_b16 v[130:131], v207 offset:23296
  ds_read_b64_tr_b16 v[132:133], v206 offset:8992
  ds_read_b64_tr_b16 v[134:135], v206 offset:23328
  s_add_u32 m0, s79, 8192
  s_nop 0
  buffer_load_dwordx4 v60, s[12:15], s82 offen lds
  ds_read_b64_tr_b16 v[136:137], v206 offset:10752
  ds_read_b64_tr_b16 v[138:139], v206 offset:25088
  ds_read_b64_tr_b16 v[140:141], v207 offset:10752
  ds_read_b64_tr_b16 v[142:143], v207 offset:25088
  ds_read_b64_tr_b16 v[144:145], v206 offset:10784
  ds_read_b64_tr_b16 v[146:147], v206 offset:25120
  ds_read_b64_tr_b16 v[148:149], v206 offset:12544
  s_add_u32 m0, s79, 9216
  s_nop 0
  buffer_load_dwordx4 v60, s[12:15], s83 offen lds
  ds_read_b64_tr_b16 v[150:151], v206 offset:26880
  ds_read_b64_tr_b16 v[152:153], v207 offset:12544
  ds_read_b64_tr_b16 v[154:155], v207 offset:26880
  ds_read_b64_tr_b16 v[156:157], v206 offset:12576
  ds_read_b64_tr_b16 v[158:159], v206 offset:26912
  s_waitcnt lgkmcnt(0)
  s_waitcnt vmcnt(8)
  s_barrier
  s_add_u32 s82, s28, 2
  s_and_b32 s82, s82, 7
  s_lshl_b32 s82, s82, 7
  s_add_u32 s82, s82, s77
  s_add_u32 m0, s80, 98304
  s_nop 0
  buffer_load_dwordx4 v62, s[4:7], s82 offen lds
  s_add_u32 s82, s82, 32768
  s_add_u32 m0, s80, 102400
  s_nop 0
  buffer_load_dwordx4 v62, s[4:7], s82 offen lds
  s_add_u32 s82, s82, 32768
  s_add_u32 m0, s80, 106496
  s_nop 0
  buffer_load_dwordx4 v62, s[4:7], s82 offen lds
  s_setprio 2
  v_mfma_f32_16x16x32_bf16 v[48:51], v[64:67], v[68:71], v[48:51]
  v_mfma_f32_16x16x32_bf16 v[52:55], v[72:75], v[68:71], v[52:55]
  v_mfma_f32_16x16x32_bf16 v[48:51], v[76:79], v[80:83], v[48:51]
  v_mfma_f32_16x16x32_bf16 v[52:55], v[84:87], v[80:83], v[52:55]
  v_mfma_f32_16x16x32_bf16 v[48:51], v[88:91], v[92:95], v[48:51]
  v_mfma_f32_16x16x32_bf16 v[52:55], v[96:99], v[92:95], v[52:55]
  v_mfma_f32_16x16x32_bf16 v[48:51], v[100:103], v[104:107], v[48:51]
  v_mfma_f32_16x16x32_bf16 v[52:55], v[108:111], v[104:107], v[52:55]
  v_mfma_f32_16x16x32_bf16 v[48:51], v[112:115], v[116:119], v[48:51]
  v_mfma_f32_16x16x32_bf16 v[52:55], v[120:123], v[116:119], v[52:55]
  v_mfma_f32_16x16x32_bf16 v[48:51], v[124:127], v[128:131], v[48:51]
  v_mfma_f32_16x16x32_bf16 v[52:55], v[132:135], v[128:131], v[52:55]
  v_mfma_f32_16x16x32_bf16 v[48:51], v[136:139], v[140:143], v[48:51]
  v_mfma_f32_16x16x32_bf16 v[52:55], v[144:147], v[140:143], v[52:55]
  v_mfma_f32_16x16x32_bf16 v[48:51], v[148:151], v[152:155], v[48:51]
  v_mfma_f32_16x16x32_bf16 v[52:55], v[156:159], v[152:155], v[52:55]
  s_setprio 0
  s_add_u32 s82, s82, 32768
  s_add_u32 m0, s80, 110592
  s_nop 0
  buffer_load_dwordx4 v62, s[4:7], s82 offen lds
  s_add_u32 s82, s28, 2
  s_and_b32 s82, s82, 7
  s_mul_i32 s82, s82, 229376
  s_add_u32 s82, s82, s66
  s_add_u32 s83, s82, 14336
  s_add_u32 m0, s79, 114688
  s_nop 0
  buffer_load_dwordx4 v60, s[8:11], s82 offen lds
  s_add_u32 m0, s79, 115712
  s_nop 0
  buffer_load_dwordx4 v60, s[8:11], s83 offen lds
  v_cvt_pk_bf16_f32 v48, v48, v49
  v_cvt_pk_bf16_f32 v50, v50, v51
  v_cvt_pk_bf16_f32 v52, v52, v53
  v_cvt_pk_bf16_f32 v54, v54, v55
  ds_write_b32 v208, v48
  ds_write_b32 v209, v50
  s_mov_b32 exec_hi, 0
  ds_write_b16 v210, v52 offset:1024
  s_mov_b32 exec_lo, 0xffff
  ds_write_b16_d16_hi v210, v52 offset:1088
  ds_write_b16 v210, v54 offset:1152
  ds_write_b16_d16_hi v210, v54 offset:1216
  s_mov_b64 exec, -1
  s_waitcnt lgkmcnt(0)
  s_add_u32 m0, s79, 122880
  s_nop 0
  buffer_load_dwordx4 v60, s[12:15], s82 offen lds
  s_add_u32 m0, s79, 123904
  s_nop 0
  buffer_load_dwordx4 v60, s[12:15], s83 offen lds
  s_waitcnt vmcnt(12)
  s_barrier
  s_add_u32 s82, s28, 3
  s_and_b32 s82, s82, 7
  s_lshl_b32 s82, s82, 7
  s_add_u32 s82, s82, s77
  s_add_u32 m0, s80, 65536
  s_nop 0
  buffer_load_dwordx4 v62, s[4:7], s82 offen lds
  s_add_u32 s82, s82, 32768
  s_add_u32 m0, s80, 69632
  s_nop 0
  buffer_load_dwordx4 v62, s[4:7], s82 offen lds
  s_add_u32 s82, s28, 3
  s_and_b32 s82, s82, 7
  s_mul_i32 s82, s82, 229376
  s_add_u32 s82, s82, s66
  s_add_u32 s83, s82, 14336
  s_add_u32 m0, s79, 16384
  s_nop 0
  buffer_load_dwordx4 v60, s[8:11], s82 offen lds
  s_add_u32 m0, s79, 17408
  s_nop 0
  buffer_load_dwordx4 v60, s[8:11], s83 offen lds
  s_add_u32 m0, s79, 24576
  s_nop 0
  buffer_load_dwordx4 v60, s[12:15], s82 offen lds
  s_add_u32 m0, s79, 25600
  s_nop 0
  buffer_load_dwordx4 v60, s[12:15], s83 offen lds
  s_add_u32 s82, s28, 3
  s_and_b32 s82, s82, 7
  s_lshl_b32 s82, s82, 7
  s_add_u32 s82, s82, s77
  s_add_u32 s82, s82, 32768
  s_add_u32 s82, s82, 32768
  s_add_u32 m0, s80, 73728
  s_nop 0
  buffer_load_dwordx4 v62, s[4:7], s82 offen lds
  s_add_u32 s82, s82, 32768
  s_add_u32 m0, s80, 77824
  s_nop 0
  buffer_load_dwordx4 v62, s[4:7], s82 offen lds
  s_waitcnt vmcnt(8)
  s_barrier
  s_add_u32 m0, s30, 0
  s_add_u32 s82, s29, 0
  buffer_load_dwordx4 v219, s[24:27], s82 offen lds
  s_add_u32 m0, s30, 1024
  s_add_u32 s82, s29, 8192
  buffer_load_dwordx4 v218, s[24:27], s82 offen lds
  s_add_u32 m0, s30, 2048
  s_add_u32 s82, s29, 32768
  buffer_load_dwordx4 v219, s[24:27], s82 offen lds
  s_add_u32 m0, s30, 3072
  s_add_u32 s82, s29, 40960
  buffer_load_dwordx4 v218, s[24:27], s82 offen lds
  s_add_u32 s82, s28, 3
  s_and_b32 s82, s82, 7
  s_mul_i32 s82, s82, 229376
  s_add_u32 s82, s82, s66
  s_add_u32 s82, s82, 114688
  s_add_u32 s83, s82, 14336
  s_add_u32 m0, s79, 32768
  s_nop 0
  buffer_load_dwordx4 v60, s[8:11], s82 offen lds
  s_add_u32 m0, s79, 33792
  s_nop 0
  buffer_load_dwordx4 v60, s[8:11], s83 offen lds
  s_add_u32 m0, s79, 40960
  s_nop 0
  buffer_load_dwordx4 v60, s[12:15], s82 offen lds
  s_add_u32 m0, s79, 41984
  s_nop 0
  buffer_load_dwordx4 v60, s[12:15], s83 offen lds
  s_add_u32 s82, s28, 4
  s_and_b32 s82, s82, 7
  s_lshl_b32 s82, s82, 7
  s_add_u32 s82, s82, s77
  s_add_u32 m0, s80, 81920
  s_nop 0
  buffer_load_dwordx4 v62, s[4:7], s82 offen lds
  s_add_u32 s82, s82, 32768
  s_add_u32 m0, s80, 86016
  s_nop 0
  buffer_load_dwordx4 v62, s[4:7], s82 offen lds
  s_waitcnt vmcnt(26)
  s_barrier
  s_add_u32 s82, s28, 4
  s_and_b32 s82, s82, 7
  s_mul_i32 s82, s82, 229376
  s_add_u32 s82, s82, s66
  s_add_u32 s83, s82, 14336
  s_add_u32 m0, s79, 49152
  s_nop 0
  buffer_load_dwordx4 v60, s[8:11], s82 offen lds
  s_add_u32 m0, s79, 50176
  s_nop 0
  buffer_load_dwordx4 v60, s[8:11], s83 offen lds
  s_add_u32 m0, s79, 57344
  s_nop 0
  buffer_load_dwordx4 v60, s[12:15], s82 offen lds
  s_add_u32 m0, s79, 58368
  s_nop 0
  buffer_load_dwordx4 v60, s[12:15], s83 offen lds
  s_add_u32 s82, s28, 4
  s_and_b32 s82, s82, 7
  s_lshl_b32 s82, s82, 7
  s_add_u32 s82, s82, s77
  s_add_u32 s82, s82, 32768
  s_add_u32 s82, s82, 32768
  s_add_u32 m0, s80, 90112
  s_nop 0
  buffer_load_dwordx4 v62, s[4:7], s82 offen lds
  s_add_u32 s82, s82, 32768
  s_add_u32 m0, s80, 94208
  s_nop 0
  buffer_load_dwordx4 v62, s[4:7], s82 offen lds
  s_waitcnt vmcnt(12)
  s_barrier
  s_add_u32 s82, s28, 4
  s_and_b32 s82, s82, 7
  s_mul_i32 s82, s82, 229376
  s_add_u32 s82, s82, s66
  s_add_u32 s82, s82, 114688
  s_add_u32 s83, s82, 14336
  s_add_u32 m0, s79, 114688
  s_nop 0
  buffer_load_dwordx4 v60, s[8:11], s82 offen lds
  s_add_u32 m0, s79, 115712
  s_nop 0
  buffer_load_dwordx4 v60, s[8:11], s83 offen lds
  s_add_u32 m0, s79, 122880
  s_nop 0
  buffer_load_dwordx4 v60, s[12:15], s82 offen lds
  s_add_u32 m0, s79, 123904
  s_nop 0
  buffer_load_dwordx4 v60, s[12:15], s83 offen lds
  s_add_u32 s82, s28, 5
  s_and_b32 s82, s82, 7
  s_lshl_b32 s82, s82, 7
  s_add_u32 s82, s82, s77
  s_add_u32 m0, s80, 98304
  s_nop 0
  buffer_load_dwordx4 v62, s[4:7], s82 offen lds
  s_add_u32 s82, s82, 32768
  s_add_u32 m0, s80, 102400
  s_nop 0
  buffer_load_dwordx4 v62, s[4:7], s82 offen lds
  s_waitcnt vmcnt(14)
  s_barrier
  s_add_u32 m0, s30, 0
  s_add_u32 s82, s29, 65536
  buffer_load_dwordx4 v219, s[24:27], s82 offen lds
  s_add_u32 m0, s30, 1024
  s_add_u32 s82, s29, 73728
  buffer_load_dwordx4 v218, s[24:27], s82 offen lds
  s_add_u32 m0, s30, 2048
  s_add_u32 s82, s29, 98304
  buffer_load_dwordx4 v219, s[24:27], s82 offen lds
  s_add_u32 m0, s30, 3072
  s_add_u32 s82, s29, 106496
  buffer_load_dwordx4 v218, s[24:27], s82 offen lds
  s_add_u32 s82, s28, 5
  s_and_b32 s82, s82, 7
  s_mul_i32 s82, s82, 229376
  s_add_u32 s82, s82, s66
  s_add_u32 s83, s82, 14336
  s_add_u32 m0, s79, 0
  s_nop 0
  buffer_load_dwordx4 v60, s[8:11], s82 offen lds
  s_add_u32 m0, s79, 1024
  s_nop 0
  buffer_load_dwordx4 v60, s[8:11], s83 offen lds
  s_add_u32 m0, s79, 8192
  s_nop 0
  buffer_load_dwordx4 v60, s[12:15], s82 offen lds
  s_add_u32 m0, s79, 9216
  s_nop 0
  buffer_load_dwordx4 v60, s[12:15], s83 offen lds
  s_add_u32 s82, s28, 5
  s_and_b32 s82, s82, 7
  s_lshl_b32 s82, s82, 7
  s_add_u32 s82, s82, s77
  s_add_u32 s82, s82, 32768
  s_add_u32 s82, s82, 32768
  s_add_u32 m0, s80, 106496
  s_nop 0
  buffer_load_dwordx4 v62, s[4:7], s82 offen lds
  s_add_u32 s82, s82, 32768
  s_add_u32 m0, s80, 110592
  s_nop 0
  buffer_load_dwordx4 v62, s[4:7], s82 offen lds
  s_waitcnt vmcnt(16)
  s_barrier
  s_add_u32 s82, s28, 5
  s_and_b32 s82, s82, 7
  s_mul_i32 s82, s82, 229376
  s_add_u32 s82, s82, s66
  s_add_u32 s82, s82, 114688
  s_add_u32 s83, s82, 14336
  s_add_u32 m0, s79, 16384
  s_nop 0
  buffer_load_dwordx4 v60, s[8:11], s82 offen lds
  ds_read_u16 v64, v224
  ds_read_u16 v65, v225
  s_add_u32 m0, s79, 17408
  s_nop 0
  buffer_load_dwordx4 v60, s[8:11], s83 offen lds
  ds_read_u16 v66, v226
  ds_read_u16 v67, v227
  s_add_u32 m0, s79, 24576
  s_nop 0
  buffer_load_dwordx4 v60, s[12:15], s82 offen lds
  ds_read_u16 v68, v228
  ds_read_u16 v69, v229
  s_add_u32 m0, s79, 25600
  s_nop 0
  buffer_load_dwordx4 v60, s[12:15], s83 offen lds
  ds_read_u16 v70, v230
  s_add_u32 s82, s28, 6
  s_and_b32 s82, s82, 7
  s_lshl_b32 s82, s82, 7
  s_add_u32 s82, s82, s77
  s_add_u32 m0, s80, 65536
  s_nop 0
  buffer_load_dwordx4 v62, s[4:7], s82 offen lds
  ds_read_u16 v71, v231
  ds_read_u16 v72, v232
  s_add_u32 s82, s82, 32768
  s_add_u32 m0, s80, 69632
  s_nop 0
  buffer_load_dwordx4 v62, s[4:7], s82 offen lds
  ds_read_u16 v73, v233
  ds_read_u16 v74, v234
  s_waitcnt vmcnt(12)
  s_barrier
  s_add_u32 s82, s28, 6
  s_and_b32 s82, s82, 7
  s_mul_i32 s82, s82, 229376
  s_add_u32 s82, s82, s66
  s_add_u32 s83, s82, 14336
  s_add_u32 m0, s79, 32768
  s_nop 0
  buffer_load_dwordx4 v60, s[8:11], s82 offen lds
  s_add_u32 m0, s79, 33792
  s_nop 0
  buffer_load_dwordx4 v60, s[8:11], s83 offen lds
  s_add_u32 m0, s79, 40960
  s_nop 0
  buffer_load_dwordx4 v60, s[12:15], s82 offen lds
  s_add_u32 m0, s79, 41984
  s_nop 0
  buffer_load_dwordx4 v60, s[12:15], s83 offen lds
  s_add_u32 s82, s28, 6
  s_and_b32 s82, s82, 7
  s_lshl_b32 s82, s82, 7
  s_add_u32 s82, s82, s77
  s_add_u32 s82, s82, 32768
  s_add_u32 s82, s82, 32768
  s_add_u32 m0, s80, 73728
  s_nop 0
  buffer_load_dwordx4 v62, s[4:7], s82 offen lds
  s_add_u32 s82, s82, 32768
  s_add_u32 m0, s80, 77824
  s_nop 0
  buffer_load_dwordx4 v62, s[4:7], s82 offen lds
  s_waitcnt vmcnt(12)
  s_barrier
  s_add_u32 m0, s30, 0
  s_add_u32 s82, s29, 131072
  buffer_load_dwordx4 v219, s[24:27], s82 offen lds
  ds_read_u16 v75, v235
  s_add_u32 m0, s30, 1024
  s_add_u32 s82, s29, 139264
  buffer_load_dwordx4 v218, s[24:27], s82 offen lds
  ds_read_u16 v76, v236
  s_add_u32 m0, s30, 2048
  s_add_u32 s82, s29, 163840
  buffer_load_dwordx4 v219, s[24:27], s82 offen lds
  ds_read_u16 v77, v237
  s_add_u32 m0, s30, 3072
  s_add_u32 s82, s29, 172032
  buffer_load_dwordx4 v218, s[24:27], s82 offen lds
  ds_read_u16 v78, v238
  s_add_u32 s82, s28, 6
  s_and_b32 s82, s82, 7
  s_mul_i32 s82, s82, 229376
  s_add_u32 s82, s82, s66
  s_add_u32 s82, s82, 114688
  s_add_u32 s83, s82, 14336
  s_add_u32 m0, s79, 49152
  s_nop 0
  buffer_load_dwordx4 v60, s[8:11], s82 offen lds
  ds_read_u16 v79, v239
  ds_read_u16 v80, v240
  s_add_u32 m0, s79, 50176
  s_nop 0
  buffer_load_dwordx4 v60, s[8:11], s83 offen lds
  ds_read_u16 v81, v241
  s_add_u32 m0, s79, 57344
  s_nop 0
  buffer_load_dwordx4 v60, s[12:15], s82 offen lds
  ds_read_u16 v82, v242
  s_add_u32 m0, s79, 58368
  s_nop 0
  buffer_load_dwordx4 v60, s[12:15], s83 offen lds
  ds_read_u16 v83, v243
  s_add_u32 s82, s28, 7
  s_and_b32 s82, s82, 7
  s_lshl_b32 s82, s82, 7
  s_add_u32 s82, s82, s77
  s_add_u32 m0, s80, 81920
  s_nop 0
  buffer_load_dwordx4 v62, s[4:7], s82 offen lds
  ds_read_u16 v84, v244
  s_add_u32 s82, s82, 32768
  s_add_u32 m0, s80, 86016
  s_nop 0
  buffer_load_dwordx4 v62, s[4:7], s82 offen lds
  ds_read_u16 v85, v245
  s_waitcnt vmcnt(18)
  s_barrier
  s_add_u32 s82, s28, 7
  s_and_b32 s82, s82, 7
  s_lshl_b32 s82, s82, 7
  s_add_u32 s82, s82, s77
  s_add_u32 s82, s82, 32768
  s_add_u32 s82, s82, 32768
  s_add_u32 m0, s80, 90112
  s_nop 0
  buffer_load_dwordx4 v62, s[4:7], s82 offen lds
  s_waitcnt lgkmcnt(0)
  v_cndmask_b32 v64, v64, 0, s[22:23]
  v_cndmask_b32 v65, v65, 0, s[22:23]
  v_cndmask_b32 v66, v66, 0, s[22:23]
  v_lshl_or_b32 v96, v70, 16, v71
  v_lshl_or_b32 v97, v68, 16, v69
  s_add_u32 s82, s82, 32768
  s_add_u32 m0, s80, 94208
  s_nop 0
  buffer_load_dwordx4 v62, s[4:7], s82 offen lds
  v_lshl_or_b32 v98, v66, 16, v67
  v_lshl_or_b32 v99, v64, 16, v65
  v_lshl_or_b32 v100, v71, 16, v72
  v_lshl_or_b32 v101, v69, 16, v70
  v_lshl_or_b32 v102, v67, 16, v68
  v_lshl_or_b32 v103, v65, 16, v66
  s_add_u32 s82, s28, 7
  s_and_b32 s82, s82, 7
  s_mul_i32 s82, s82, 229376
  s_add_u32 s82, s82, s66
  s_add_u32 s83, s82, 14336
  s_add_u32 m0, s79, 0
  s_nop 0
  buffer_load_dwordx4 v60, s[8:11], s82 offen lds
  v_lshl_or_b32 v104, v72, 16, v73
  v_lshl_or_b32 v105, v70, 16, v71
  v_lshl_or_b32 v106, v68, 16, v69
  v_lshl_or_b32 v107, v66, 16, v67
  v_lshl_or_b32 v108, v73, 16, v74
  v_lshl_or_b32 v109, v71, 16, v72
  s_add_u32 m0, s79, 1024
  s_nop 0
  buffer_load_dwordx4 v60, s[8:11], s83 offen lds
  v_lshl_or_b32 v110, v69, 16, v70
  v_lshl_or_b32 v111, v67, 16, v68
  v_lshl_or_b32 v112, v81, 16, v82
  v_lshl_or_b32 v113, v79, 16, v80
  v_lshl_or_b32 v114, v77, 16, v78
  v_lshl_or_b32 v115, v75, 16, v76
  s_add_u32 m0, s79, 8192
  s_nop 0
  buffer_load_dwordx4 v60, s[12:15], s82 offen lds
  v_lshl_or_b32 v116, v82, 16, v83
  v_lshl_or_b32 v117, v80, 16, v81
  v_lshl_or_b32 v118, v78, 16, v79
  v_lshl_or_b32 v119, v76, 16, v77
  v_lshl_or_b32 v120, v83, 16, v84
  v_lshl_or_b32 v121, v81, 16, v82
  s_add_u32 m0, s79, 9216
  s_nop 0
  buffer_load_dwordx4 v60, s[12:15], s83 offen lds
  v_lshl_or_b32 v122, v79, 16, v80
  v_lshl_or_b32 v123, v77, 16, v78
  v_lshl_or_b32 v124, v84, 16, v85
  v_lshl_or_b32 v125, v82, 16, v83
  v_lshl_or_b32 v126, v80, 16, v81
  v_lshl_or_b32 v127, v78, 16, v79
  s_waitcnt vmcnt(12)
  s_barrier
  s_add_u32 s82, s28, 7
  s_and_b32 s82, s82, 7
  s_mul_i32 s82, s82, 229376
  s_add_u32 s82, s82, s66
  s_add_u32 s82, s82, 114688
  s_add_u32 s83, s82, 14336
  s_add_u32 m0, s79, 16384
  s_nop 0
  buffer_load_dwordx4 v60, s[8:11], s82 offen lds
  s_add_u32 m0, s79, 17408
  s_nop 0
  buffer_load_dwordx4 v60, s[8:11], s83 offen lds
  s_add_u32 m0, s79, 24576
  s_nop 0
  buffer_load_dwordx4 v60, s[12:15], s82 offen lds
  s_add_u32 m0, s79, 25600
  s_nop 0
  buffer_load_dwordx4 v60, s[12:15], s83 offen lds
  s_waitcnt vmcnt(12)
  s_barrier
  s_cmp_eq_u32 s3, 0
  s_cselect_b32 s73, 0, 0x1000
  v_mov_b32 v4, s73
  s_mov_b32 s12, s62
  s_mov_b32 s13, s63
  s_mov_b32 s14, 0x100
  s_mov_b32 s15, 0x20000
  buffer_load_dword v19, v4, s[12:15], 0 offen offset:132 sc1
  v_mov_b32 v20, 0
  v_mov_b32 v21, 0
  v_mov_b32 v22, 0
  v_mov_b32 v23, 0
  s_add_u32 s73, s29, 221184
  buffer_load_dwordx4 v[164:167], v218, s[24:27], s73 offen
  s_add_u32 s73, s29, 245760
  buffer_load_dwordx4 v[168:171], v219, s[24:27], s73 offen
  s_add_u32 s73, s29, 253952
  buffer_load_dwordx4 v[172:175], v218, s[24:27], s73 offen
  s_add_u32 s73, s29, 278528
  buffer_load_dwordx4 v[176:179], v219, s[24:27], s73 offen
  s_add_u32 s73, s29, 286720
  buffer_load_dwordx4 v[180:183], v218, s[24:27], s73 offen
  s_add_u32 s73, s29, 311296
  buffer_load_dwordx4 v[184:187], v219, s[24:27], s73 offen
  s_add_u32 s73, s29, 319488
  buffer_load_dwordx4 v[188:191], v218, s[24:27], s73 offen
  s_waitcnt vmcnt(8) lgkmcnt(0)
  s_barrier
H_JOIN:
  s_setprio 0
  s_cmp_eq_u32 s3, 0
  s_cbranch_scc0 H_P2
  s_mov_b32 s76, 0x40000
  s_waitcnt vmcnt(7)
H_POLL:
  v_readfirstlane_b32 s73, v19
  s_nop 0
  s_cmp_ge_u32 s73, 32
  s_cbranch_scc1 H_P1
  s_sleep 6
  global_load_dword v19, v214, s[62:63] offset:132 sc1
  s_waitcnt vmcnt(0)
  s_sub_u32 s76, s76, 1
  s_cbranch_scc0 H_POLL
H_P1:
  v_mov_b32 v18, 32
  v_mov_b32 v19, 32
  ds_write_b64 v212, v[18:19]
H_P2:
  s_mov_b32 s76, 0x40000
L1:
  ds_read_b32 v19, v213
  s_waitcnt lgkmcnt(0)
  v_readfirstlane_b32 s73, v19
  s_nop 0
  s_cmp_ge_u32 s73, 32
  s_cbranch_scc1 L2
  s_sleep 1
  s_sub_u32 s76, s76, 1
  s_cbranch_scc0 L1
L2:
  s_lshl_b32 s73, s70, 12
  s_lshl_b32 s74, s71, 11
  s_add_u32 s73, s73, s74
  s_add_u32 s74, s73, 0x900000
  buffer_load_dwordx4 v[248:251], v203, s[16:19], s74 offen sc1
  buffer_load_dwordx4 v[252:255], v203, s[16:19], s74 offen offset:1024 sc1
  ds_write_b128 v192, v[20:23] offset:17664
  s_add_u32 s73, s29, 81920
  buffer_load_dwordx4 v[128:131], v219, s[24:27], s73 offen
  ds_write_b128 v193, v[20:23] offset:0
  s_add_u32 s73, s29, 90112
  buffer_load_dwordx4 v[132:135], v218, s[24:27], s73 offen
  ds_write_b128 v193, v[20:23] offset:4416
  s_add_u32 s73, s29, 114688
  buffer_load_dwordx4 v[136:139], v219, s[24:27], s73 offen
  ds_write_b64 v194, v[20:21] offset:18784
  s_add_u32 s73, s29, 122880
  buffer_load_dwordx4 v[140:143], v218, s[24:27], s73 offen
  ds_write_b128 v197, v[96:99] offset:112
  s_add_u32 s73, s29, 147456
  buffer_load_dwordx4 v[144:147], v219, s[24:27], s73 offen
  ds_write_b128 v197, v[100:103] offset:4528
  s_add_u32 s73, s29, 155648
  buffer_load_dwordx4 v[148:151], v218, s[24:27], s73 offen
  ds_write_b128 v197, v[104:107] offset:8944
  s_add_u32 s73, s29, 180224
  buffer_load_dwordx4 v[152:155], v219, s[24:27], s73 offen
  ds_write_b128 v197, v[108:111] offset:13360
  s_add_u32 s73, s29, 188416
  buffer_load_dwordx4 v[156:159], v218, s[24:27], s73 offen
  ds_write_b128 v197, v[112:115] offset:1136
  s_add_u32 s73, s29, 212992
  buffer_load_dwordx4 v[160:163], v219, s[24:27], s73 offen
  ds_write_b128 v197, v[116:119] offset:5552
  ds_write_b128 v197, v[120:123] offset:9968
  ds_write_b128 v197, v[124:127] offset:14384
  s_waitcnt vmcnt(9)
  ds_write_b128 v195, v[248:251] offset:25056
  ds_write_b64 v195, v[248:249] offset:18792
  ds_write_b64 v196, v[250:251] offset:18784
  ds_write_b128 v195, v[252:255] offset:26336
  ds_write_b64 v195, v[252:253] offset:20072
  ds_write_b64 v196, v[254:255] offset:20064
  s_waitcnt lgkmcnt(0)
  v_mov_b32 v7, 3
  ds_write_b32 v221, v7
  s_mov_b32 s76, 0x40000
L3:
  ds_read_b32 v7, v222
  s_waitcnt lgkmcnt(0)
  v_readfirstlane_b32 s73, v7
  s_nop 0
  s_cmp_ge_u32 s73, 3
  s_cbranch_scc1 L4
  s_sleep 1
  s_sub_u32 s76, s76, 1
  s_cbranch_scc0 L3
L4:
  v_mov_b32 v4, 163808
  s_mov_b32 s76, 0x40000
L5:
  ds_read_b32 v5, v4
  s_waitcnt lgkmcnt(0)
  v_readfirstlane_b32 s73, v5
  s_nop 0
  s_cmp_ge_u32 s73, 4
  s_cbranch_scc1 L6
  s_sleep 1
  s_sub_u32 s76, s76, 1
  s_cbranch_scc0 L5
L6:
  s_cmp_eq_u32 s3, 0
  s_cbranch_scc0 CV_Q0
  global_load_dword v19, v214, s[62:63] offset:128 sc1
CV_Q0:
  s_mul_i32 s30, s3, 20480
  s_cmp_eq_u32 s81, 1
  s_cbranch_scc1 L7
  s_mov_b32 s76, 0x40000
L8:
  ds_read_b32 v5, v4
  s_waitcnt lgkmcnt(0)
  v_readfirstlane_b32 s73, v5
  s_nop 0
  s_cmp_ge_u32 s73, 8
  s_cbranch_scc1 L9
  s_sleep 1
  s_sub_u32 s76, s76, 1
  s_cbranch_scc0 L8
L9:
L7:
  s_setprio 1
  ds_read_b128 v[32:35], v202 offset:480
  ds_read_b128 v[64:67], v201 offset:3136
  ds_read_b128 v[68:71], v201 offset:3200
  ds_read_b128 v[36:39], v202 offset:1760
  ds_read_b128 v[72:75], v201 offset:2112
  ds_read_b128 v[76:79], v201 offset:2176
  ds_read_b128 v[40:43], v202 offset:3040
  ds_read_b128 v[80:83], v201 offset:1088
  ds_read_b128 v[84:87], v201 offset:1152
  s_waitcnt lgkmcnt(6)
  v_mfma_f32_16x16x32_bf16 v[120:123], v[64:67], v[32:35], 0
  ds_read_b128 v[44:47], v202 offset:4320
  ds_read_b128 v[88:91], v201 offset:64
  v_mfma_f32_16x16x32_bf16 v[124:127], v[68:71], v[32:35], 0
  ds_read_b128 v[92:95], v201 offset:128
  s_waitcnt lgkmcnt(6)
  v_mfma_f32_16x16x32_bf16 v[112:115], v[72:75], v[32:35], 0
  ds_read_b128 v[48:51], v202 offset:544
  v_mfma_f32_16x16x32_bf16 v[116:119], v[76:79], v[32:35], 0
  ds_read_b128 v[64:67], v201 offset:3072
  v_mfma_f32_16x16x32_bf16 v[120:123], v[72:75], v[36:39], v[120:123]
  ds_read_b128 v[68:71], v201 offset:3136
  v_mfma_f32_16x16x32_bf16 v[124:127], v[76:79], v[36:39], v[124:127]
  s_add_u32 m0, s30, 0
  s_add_u32 s82, s29, 196608
  buffer_load_dwordx4 v219, s[24:27], s82 offen lds
  s_waitcnt lgkmcnt(6)
  v_mfma_f32_16x16x32_bf16 v[104:107], v[80:83], v[32:35], 0
  ds_read_b128 v[52:55], v202 offset:1824
  v_mfma_f32_16x16x32_bf16 v[108:111], v[84:87], v[32:35], 0
  ds_read_b128 v[72:75], v201 offset:2048
  v_mfma_f32_16x16x32_bf16 v[112:115], v[80:83], v[36:39], v[112:115]
  ds_read_b128 v[76:79], v201 offset:2112
  v_mfma_f32_16x16x32_bf16 v[116:119], v[84:87], v[36:39], v[116:119]
  s_add_u32 m0, s30, 1024
  s_add_u32 s82, s29, 204800
  buffer_load_dwordx4 v218, s[24:27], s82 offen lds
  v_mfma_f32_16x16x32_bf16 v[120:123], v[80:83], v[40:43], v[120:123]
  v_mfma_f32_16x16x32_bf16 v[124:127], v[84:87], v[40:43], v[124:127]
  s_waitcnt lgkmcnt(6)
  v_mfma_f32_16x16x32_bf16 v[96:99], v[88:91], v[32:35], 0
  ds_read_b128 v[56:59], v202 offset:3104
  v_mfma_f32_16x16x32_bf16 v[100:103], v[92:95], v[32:35], 0
  ds_read_b128 v[80:83], v201 offset:1024
  v_mfma_f32_16x16x32_bf16 v[104:107], v[88:91], v[36:39], v[104:107]
  ds_read_b128 v[84:87], v201 offset:1088
  v_mfma_f32_16x16x32_bf16 v[108:111], v[92:95], v[36:39], v[108:111]
  s_add_u32 m0, s30, 2048
  s_add_u32 s82, s29, 229376
  buffer_load_dwordx4 v219, s[24:27], s82 offen lds
  v_mfma_f32_16x16x32_bf16 v[112:115], v[88:91], v[40:43], v[112:115]
  s_add_u32 m0, s30, 3072
  s_add_u32 s82, s29, 237568
  buffer_load_dwordx4 v218, s[24:27], s82 offen lds
  v_mfma_f32_16x16x32_bf16 v[116:119], v[92:95], v[40:43], v[116:119]
  v_mfma_f32_16x16x32_bf16 v[120:123], v[88:91], v[44:47], v[120:123]
  v_mfma_f32_16x16x32_bf16 v[124:127], v[92:95], v[44:47], v[124:127]
  s_waitcnt lgkmcnt(6)
  v_mfma_f32_16x16x32_bf16 v[120:123], v[64:67], v[48:51], v[120:123]
  ds_read_b128 v[60:63], v202 offset:4384
  ds_read_b128 v[88:91], v201 offset:0
  v_mfma_f32_16x16x32_bf16 v[124:127], v[68:71], v[48:51], v[124:127]
  ds_read_b128 v[92:95], v201 offset:64
  s_waitcnt lgkmcnt(6)
  v_mfma_f32_16x16x32_bf16 v[112:115], v[72:75], v[48:51], v[112:115]
  ds_read_b128 v[32:35], v202 offset:320
  v_mfma_f32_16x16x32_bf16 v[116:119], v[76:79], v[48:51], v[116:119]
  ds_read_b128 v[64:67], v201 offset:3264
  v_mfma_f32_16x16x32_bf16 v[120:123], v[72:75], v[52:55], v[120:123]
  ds_read_b128 v[68:71], v201 offset:3328
  v_mfma_f32_16x16x32_bf16 v[124:127], v[76:79], v[52:55], v[124:127]
  s_add_u32 m0, s30, 4096
  s_add_u32 s82, s29, 262144
  buffer_load_dwordx4 v219, s[24:27], s82 offen lds
  s_waitcnt lgkmcnt(6)
  v_mfma_f32_16x16x32_bf16 v[104:107], v[80:83], v[48:51], v[104:107]
  ds_read_b128 v[36:39], v202 offset:1600
  v_mfma_f32_16x16x32_bf16 v[108:111], v[84:87], v[48:51], v[108:111]
  ds_read_b128 v[72:75], v201 offset:2240
  v_mfma_f32_16x16x32_bf16 v[112:115], v[80:83], v[52:55], v[112:115]
  ds_read_b128 v[76:79], v201 offset:2304
  v_mfma_f32_16x16x32_bf16 v[116:119], v[84:87], v[52:55], v[116:119]
  s_add_u32 m0, s30, 5120
  s_add_u32 s82, s29, 270336
  buffer_load_dwordx4 v218, s[24:27], s82 offen lds
  v_mfma_f32_16x16x32_bf16 v[120:123], v[80:83], v[56:59], v[120:123]
  v_mfma_f32_16x16x32_bf16 v[124:127], v[84:87], v[56:59], v[124:127]
  s_waitcnt lgkmcnt(6)
  v_mfma_f32_16x16x32_bf16 v[96:99], v[88:91], v[48:51], v[96:99]
  ds_read_b128 v[40:43], v202 offset:2880
  v_mfma_f32_16x16x32_bf16 v[100:103], v[92:95], v[48:51], v[100:103]
  ds_read_b128 v[80:83], v201 offset:1216
  v_mfma_f32_16x16x32_bf16 v[104:107], v[88:91], v[52:55], v[104:107]
  ds_read_b128 v[84:87], v201 offset:1280
  v_mfma_f32_16x16x32_bf16 v[108:111], v[92:95], v[52:55], v[108:111]
  s_add_u32 m0, s30, 6144
  s_add_u32 s82, s29, 294912
  buffer_load_dwordx4 v219, s[24:27], s82 offen lds
  v_mfma_f32_16x16x32_bf16 v[112:115], v[88:91], v[56:59], v[112:115]
  s_add_u32 m0, s30, 7168
  s_add_u32 s82, s29, 303104
  buffer_load_dwordx4 v218, s[24:27], s82 offen lds
  v_mfma_f32_16x16x32_bf16 v[116:119], v[92:95], v[56:59], v[116:119]
  v_mfma_f32_16x16x32_bf16 v[120:123], v[88:91], v[60:63], v[120:123]
  v_mfma_f32_16x16x32_bf16 v[124:127], v[92:95], v[60:63], v[124:127]
  s_waitcnt lgkmcnt(6)
  v_mfma_f32_16x16x32_bf16 v[120:123], v[64:67], v[32:35], v[120:123]
  ds_read_b128 v[44:47], v202 offset:4160
  ds_read_b128 v[88:91], v201 offset:192
  v_mfma_f32_16x16x32_bf16 v[124:127], v[68:71], v[32:35], v[124:127]
  ds_read_b128 v[92:95], v201 offset:256
  s_waitcnt lgkmcnt(6)
  v_mfma_f32_16x16x32_bf16 v[112:115], v[72:75], v[32:35], v[112:115]
  ds_read_b128 v[48:51], v202 offset:384
  v_mfma_f32_16x16x32_bf16 v[116:119], v[76:79], v[32:35], v[116:119]
  ds_read_b128 v[64:67], v201 offset:3200
  v_mfma_f32_16x16x32_bf16 v[120:123], v[72:75], v[36:39], v[120:123]
  ds_read_b128 v[68:71], v201 offset:3264
  v_mfma_f32_16x16x32_bf16 v[124:127], v[76:79], v[36:39], v[124:127]
  s_add_u32 m0, s30, 8192
  s_add_u32 s82, s29, 327680
  buffer_load_dwordx4 v219, s[24:27], s82 offen lds
  s_waitcnt lgkmcnt(6)
  v_mfma_f32_16x16x32_bf16 v[104:107], v[80:83], v[32:35], v[104:107]
  ds_read_b128 v[52:55], v202 offset:1664
  v_mfma_f32_16x16x32_bf16 v[108:111], v[84:87], v[32:35], v[108:111]
  ds_read_b128 v[72:75], v201 offset:2176
  v_mfma_f32_16x16x32_bf16 v[112:115], v[80:83], v[36:39], v[112:115]
  ds_read_b128 v[76:79], v201 offset:2240
  v_mfma_f32_16x16x32_bf16 v[116:119], v[84:87], v[36:39], v[116:119]
  s_add_u32 m0, s30, 9216
  s_add_u32 s82, s29, 335872
  buffer_load_dwordx4 v218, s[24:27], s82 offen lds
  v_mfma_f32_16x16x32_bf16 v[120:123], v[80:83], v[40:43], v[120:123]
  v_mfma_f32_16x16x32_bf16 v[124:127], v[84:87], v[40:43], v[124:127]
  s_waitcnt lgkmcnt(6)
  v_mfma_f32_16x16x32_bf16 v[96:99], v[88:91], v[32:35], v[96:99]
  ds_read_b128 v[56:59], v202 offset:2944
  v_mfma_f32_16x16x32_bf16 v[100:103], v[92:95], v[32:35], v[100:103]
  ds_read_b128 v[80:83], v201 offset:1152
  v_mfma_f32_16x16x32_bf16 v[104:107], v[88:91], v[36:39], v[104:107]
  ds_read_b128 v[84:87], v201 offset:1216
  v_mfma_f32_16x16x32_bf16 v[108:111], v[92:95], v[36:39], v[108:111]
  s_add_u32 m0, s30, 10240
  s_add_u32 s82, s29, 360448
  buffer_load_dwordx4 v219, s[24:27], s82 offen lds
  v_mfma_f32_16x16x32_bf16 v[112:115], v[88:91], v[40:43], v[112:115]
  s_add_u32 m0, s30, 11264
  s_add_u32 s82, s29, 368640
  buffer_load_dwordx4 v218, s[24:27], s82 offen lds
  v_mfma_f32_16x16x32_bf16 v[116:119], v[92:95], v[40:43], v[116:119]
  v_mfma_f32_16x16x32_bf16 v[120:123], v[88:91], v[44:47], v[120:123]
  v_mfma_f32_16x16x32_bf16 v[124:127], v[92:95], v[44:47], v[124:127]
  s_waitcnt lgkmcnt(6)
  v_mfma_f32_16x16x32_bf16 v[120:123], v[64:67], v[48:51], v[120:123]
  ds_read_b128 v[60:63], v202 offset:4224
  ds_read_b128 v[88:91], v201 offset:128
  v_mfma_f32_16x16x32_bf16 v[124:127], v[68:71], v[48:51], v[124:127]
  ds_read_b128 v[92:95], v201 offset:192
  s_waitcnt lgkmcnt(6)
  v_mfma_f32_16x16x32_bf16 v[112:115], v[72:75], v[48:51], v[112:115]
  ds_read_b128 v[32:35], v202 offset:160
  v_mfma_f32_16x16x32_bf16 v[116:119], v[76:79], v[48:51], v[116:119]
  ds_read_b128 v[64:67], v201 offset:3392
  v_mfma_f32_16x16x32_bf16 v[120:123], v[72:75], v[52:55], v[120:123]
  ds_read_b128 v[68:71], v201 offset:3456
  v_mfma_f32_16x16x32_bf16 v[124:127], v[76:79], v[52:55], v[124:127]
  s_add_u32 m0, s30, 12288
  s_add_u32 s82, s29, 393216
  buffer_load_dwordx4 v219, s[24:27], s82 offen lds
  s_waitcnt lgkmcnt(6)
  v_mfma_f32_16x16x32_bf16 v[104:107], v[80:83], v[48:51], v[104:107]
  ds_read_b128 v[36:39], v202 offset:1440
  v_mfma_f32_16x16x32_bf16 v[108:111], v[84:87], v[48:51], v[108:111]
  ds_read_b128 v[72:75], v201 offset:2368
  v_mfma_f32_16x16x32_bf16 v[112:115], v[80:83], v[52:55], v[112:115]
  ds_read_b128 v[76:79], v201 offset:2432
  v_mfma_f32_16x16x32_bf16 v[116:119], v[84:87], v[52:55], v[116:119]
  s_add_u32 m0, s30, 13312
  s_add_u32 s82, s29, 401408
  buffer_load_dwordx4 v218, s[24:27], s82 offen lds
  v_mfma_f32_16x16x32_bf16 v[120:123], v[80:83], v[56:59], v[120:123]
  v_mfma_f32_16x16x32_bf16 v[124:127], v[84:87], v[56:59], v[124:127]
  s_waitcnt lgkmcnt(6)
  v_mfma_f32_16x16x32_bf16 v[96:99], v[88:91], v[48:51], v[96:99]
  ds_read_b128 v[40:43], v202 offset:2720
  v_mfma_f32_16x16x32_bf16 v[100:103], v[92:95], v[48:51], v[100:103]
  ds_read_b128 v[80:83], v201 offset:1344
  v_mfma_f32_16x16x32_bf16 v[104:107], v[88:91], v[52:55], v[104:107]
  ds_read_b128 v[84:87], v201 offset:1408
  v_mfma_f32_16x16x32_bf16 v[108:111], v[92:95], v[52:55], v[108:111]
  s_add_u32 m0, s30, 14336
  s_add_u32 s82, s29, 425984
  buffer_load_dwordx4 v219, s[24:27], s82 offen lds
  v_mfma_f32_16x16x32_bf16 v[112:115], v[88:91], v[56:59], v[112:115]
  s_add_u32 m0, s30, 15360
  s_add_u32 s82, s29, 434176
  buffer_load_dwordx4 v218, s[24:27], s82 offen lds
  v_mfma_f32_16x16x32_bf16 v[116:119], v[92:95], v[56:59], v[116:119]
  v_mfma_f32_16x16x32_bf16 v[120:123], v[88:91], v[60:63], v[120:123]
  v_mfma_f32_16x16x32_bf16 v[124:127], v[92:95], v[60:63], v[124:127]
  s_waitcnt lgkmcnt(6)
  v_mfma_f32_16x16x32_bf16 v[120:123], v[64:67], v[32:35], v[120:123]
  ds_read_b128 v[44:47], v202 offset:4000
  ds_read_b128 v[88:91], v201 offset:320
  v_mfma_f32_16x16x32_bf16 v[124:127], v[68:71], v[32:35], v[124:127]
  ds_read_b128 v[92:95], v201 offset:384
  s_waitcnt lgkmcnt(6)
  v_mfma_f32_16x16x32_bf16 v[112:115], v[72:75], v[32:35], v[112:115]
  ds_read_b128 v[48:51], v202 offset:224
  v_mfma_f32_16x16x32_bf16 v[116:119], v[76:79], v[32:35], v[116:119]
  ds_read_b128 v[64:67], v201 offset:3328
  v_mfma_f32_16x16x32_bf16 v[120:123], v[72:75], v[36:39], v[120:123]
  ds_read_b128 v[68:71], v201 offset:3392
  v_mfma_f32_16x16x32_bf16 v[124:127], v[76:79], v[36:39], v[124:127]
  s_add_u32 m0, s30, 16384
  s_add_u32 s82, s29, 16384
  buffer_load_dwordx4 v219, s[24:27], s82 offen lds
  s_waitcnt lgkmcnt(6)
  v_mfma_f32_16x16x32_bf16 v[104:107], v[80:83], v[32:35], v[104:107]
  ds_read_b128 v[52:55], v202 offset:1504
  v_mfma_f32_16x16x32_bf16 v[108:111], v[84:87], v[32:35], v[108:111]
  ds_read_b128 v[72:75], v201 offset:2304
  v_mfma_f32_16x16x32_bf16 v[112:115], v[80:83], v[36:39], v[112:115]
  ds_read_b128 v[76:79], v201 offset:2368
  v_mfma_f32_16x16x32_bf16 v[116:119], v[84:87], v[36:39], v[116:119]
  s_add_u32 m0, s30, 17408
  s_add_u32 s82, s29, 24576
  buffer_load_dwordx4 v218, s[24:27], s82 offen lds
  v_mfma_f32_16x16x32_bf16 v[120:123], v[80:83], v[40:43], v[120:123]
  v_mfma_f32_16x16x32_bf16 v[124:127], v[84:87], v[40:43], v[124:127]
  s_waitcnt lgkmcnt(6)
  v_mfma_f32_16x16x32_bf16 v[96:99], v[88:91], v[32:35], v[96:99]
  ds_read_b128 v[56:59], v202 offset:2784
  v_mfma_f32_16x16x32_bf16 v[100:103], v[92:95], v[32:35], v[100:103]
  ds_read_b128 v[80:83], v201 offset:1280
  v_mfma_f32_16x16x32_bf16 v[104:107], v[88:91], v[36:39], v[104:107]
  ds_read_b128 v[84:87], v201 offset:1344
  v_mfma_f32_16x16x32_bf16 v[108:111], v[92:95], v[36:39], v[108:111]
  s_add_u32 m0, s30, 18432
  s_add_u32 s82, s29, 49152
  buffer_load_dwordx4 v219, s[24:27], s82 offen lds
  v_mfma_f32_16x16x32_bf16 v[112:115], v[88:91], v[40:43], v[112:115]
  s_add_u32 m0, s30, 19456
  s_add_u32 s82, s29, 57344
  buffer_load_dwordx4 v218, s[24:27], s82 offen lds
  v_mfma_f32_16x16x32_bf16 v[116:119], v[92:95], v[40:43], v[116:119]
  v_mfma_f32_16x16x32_bf16 v[120:123], v[88:91], v[44:47], v[120:123]
  v_mfma_f32_16x16x32_bf16 v[124:127], v[92:95], v[44:47], v[124:127]
  s_waitcnt lgkmcnt(6)
  v_mfma_f32_16x16x32_bf16 v[120:123], v[64:67], v[48:51], v[120:123]
  ds_read_b128 v[60:63], v202 offset:4064
  ds_read_b128 v[88:91], v201 offset:256
  v_mfma_f32_16x16x32_bf16 v[124:127], v[68:71], v[48:51], v[124:127]
  ds_read_b128 v[92:95], v201 offset:320
  s_waitcnt lgkmcnt(6)
  v_mfma_f32_16x16x32_bf16 v[112:115], v[72:75], v[48:51], v[112:115]
  ds_read_b128 v[32:35], v202 offset:0
  v_mfma_f32_16x16x32_bf16 v[116:119], v[76:79], v[48:51], v[116:119]
  ds_read_b128 v[64:67], v201 offset:3520
  v_mfma_f32_16x16x32_bf16 v[120:123], v[72:75], v[52:55], v[120:123]
  ds_read_b128 v[68:71], v201 offset:3584
  v_mfma_f32_16x16x32_bf16 v[124:127], v[76:79], v[52:55], v[124:127]
  s_add_u32 s82, s29, 344064
  buffer_load_dwordx4 v[224:227], v219, s[24:27], s82 offen
  s_waitcnt lgkmcnt(6)
  v_mfma_f32_16x16x32_bf16 v[104:107], v[80:83], v[48:51], v[104:107]
  ds_read_b128 v[36:39], v202 offset:1280
  v_mfma_f32_16x16x32_bf16 v[108:111], v[84:87], v[48:51], v[108:111]
  ds_read_b128 v[72:75], v201 offset:2496
  v_mfma_f32_16x16x32_bf16 v[112:115], v[80:83], v[52:55], v[112:115]
  ds_read_b128 v[76:79], v201 offset:2560
  v_mfma_f32_16x16x32_bf16 v[116:119], v[84:87], v[52:55], v[116:119]
  s_add_u32 s82, s29, 352256
  buffer_load_dwordx4 v[228:231], v218, s[24:27], s82 offen
  v_mfma_f32_16x16x32_bf16 v[120:123], v[80:83], v[56:59], v[120:123]
  v_mfma_f32_16x16x32_bf16 v[124:127], v[84:87], v[56:59], v[124:127]
  s_waitcnt lgkmcnt(6)
  v_mfma_f32_16x16x32_bf16 v[96:99], v[88:91], v[48:51], v[96:99]
  ds_read_b128 v[40:43], v202 offset:2560
  v_mfma_f32_16x16x32_bf16 v[100:103], v[92:95], v[48:51], v[100:103]
  ds_read_b128 v[80:83], v201 offset:1472
  v_mfma_f32_16x16x32_bf16 v[104:107], v[88:91], v[52:55], v[104:107]
  ds_read_b128 v[84:87], v201 offset:1536
  v_mfma_f32_16x16x32_bf16 v[108:111], v[92:95], v[52:55], v[108:111]
  s_add_u32 s82, s29, 376832
  buffer_load_dwordx4 v[232:235], v219, s[24:27], s82 offen
  v_mfma_f32_16x16x32_bf16 v[112:115], v[88:91], v[56:59], v[112:115]
  s_add_u32 s82, s29, 385024
  buffer_load_dwordx4 v[236:239], v218, s[24:27], s82 offen
  v_mfma_f32_16x16x32_bf16 v[116:119], v[92:95], v[56:59], v[116:119]
  v_mfma_f32_16x16x32_bf16 v[120:123], v[88:91], v[60:63], v[120:123]
  v_mfma_f32_16x16x32_bf16 v[124:127], v[92:95], v[60:63], v[124:127]
  s_waitcnt lgkmcnt(6)
  v_mfma_f32_16x16x32_bf16 v[120:123], v[64:67], v[32:35], v[120:123]
  ds_read_b128 v[44:47], v202 offset:3840
  ds_read_b128 v[88:91], v201 offset:448
  v_mfma_f32_16x16x32_bf16 v[124:127], v[68:71], v[32:35], v[124:127]
  ds_read_b128 v[92:95], v201 offset:512
  s_waitcnt lgkmcnt(6)
  v_mfma_f32_16x16x32_bf16 v[112:115], v[72:75], v[32:35], v[112:115]
  ds_read_b128 v[48:51], v202 offset:64
  v_mfma_f32_16x16x32_bf16 v[116:119], v[76:79], v[32:35], v[116:119]
  ds_read_b128 v[64:67], v201 offset:3456
  v_mfma_f32_16x16x32_bf16 v[120:123], v[72:75], v[36:39], v[120:123]
  ds_read_b128 v[68:71], v201 offset:3520
  v_mfma_f32_16x16x32_bf16 v[124:127], v[76:79], v[36:39], v[124:127]
  s_add_u32 s82, s29, 409600
  buffer_load_dwordx4 v[240:243], v219, s[24:27], s82 offen
  s_waitcnt lgkmcnt(6)
  v_mfma_f32_16x16x32_bf16 v[104:107], v[80:83], v[32:35], v[104:107]
  ds_read_b128 v[52:55], v202 offset:1344
  v_mfma_f32_16x16x32_bf16 v[108:111], v[84:87], v[32:35], v[108:111]
  ds_read_b128 v[72:75], v201 offset:2432
  v_mfma_f32_16x16x32_bf16 v[112:115], v[80:83], v[36:39], v[112:115]
  ds_read_b128 v[76:79], v201 offset:2496
  v_mfma_f32_16x16x32_bf16 v[116:119], v[84:87], v[36:39], v[116:119]
  s_add_u32 s82, s29, 417792
  buffer_load_dwordx4 v[244:247], v218, s[24:27], s82 offen
  v_mfma_f32_16x16x32_bf16 v[120:123], v[80:83], v[40:43], v[120:123]
  v_mfma_f32_16x16x32_bf16 v[124:127], v[84:87], v[40:43], v[124:127]
  s_waitcnt lgkmcnt(6)
  v_mov_b32 v31, 1
  s_waitcnt vmcnt(6)
  ds_write_b32 v217, v31
  v_mfma_f32_16x16x32_bf16 v[96:99], v[88:91], v[32:35], v[96:99]
  ds_read_b128 v[56:59], v202 offset:2624
  v_mfma_f32_16x16x32_bf16 v[100:103], v[92:95], v[32:35], v[100:103]
  ds_read_b128 v[80:83], v201 offset:1408
  v_mfma_f32_16x16x32_bf16 v[104:107], v[88:91], v[36:39], v[104:107]
  ds_read_b128 v[84:87], v201 offset:1472
  v_mfma_f32_16x16x32_bf16 v[108:111], v[92:95], v[36:39], v[108:111]
  s_add_u32 s82, s29, 442368
  buffer_load_dwordx4 v[248:251], v219, s[24:27], s82 offen
  v_mfma_f32_16x16x32_bf16 v[112:115], v[88:91], v[40:43], v[112:115]
  s_add_u32 s82, s29, 450560
  buffer_load_dwordx4 v[252:255], v218, s[24:27], s82 offen
  v_mfma_f32_16x16x32_bf16 v[116:119], v[92:95], v[40:43], v[116:119]
  v_mfma_f32_16x16x32_bf16 v[120:123], v[88:91], v[44:47], v[120:123]
  v_mfma_f32_16x16x32_bf16 v[124:127], v[92:95], v[44:47], v[124:127]
  s_waitcnt lgkmcnt(7)
  v_mfma_f32_16x16x32_bf16 v[120:123], v[64:67], v[48:51], v[120:123]
  ds_read_b128 v[60:63], v202 offset:3904
  ds_read_b128 v[88:91], v201 offset:384
  v_mfma_f32_16x16x32_bf16 v[124:127], v[68:71], v[48:51], v[124:127]
  ds_read_b128 v[92:95], v201 offset:448
  s_waitcnt lgkmcnt(7)
  v_mfma_f32_16x16x32_bf16 v[112:115], v[72:75], v[48:51], v[112:115]
  v_mfma_f32_16x16x32_bf16 v[116:119], v[76:79], v[48:51], v[116:119]
  v_mfma_f32_16x16x32_bf16 v[120:123], v[72:75], v[52:55], v[120:123]
  v_mfma_f32_16x16x32_bf16 v[124:127], v[76:79], v[52:55], v[124:127]
  s_waitcnt lgkmcnt(3)
  v_mfma_f32_16x16x32_bf16 v[104:107], v[80:83], v[48:51], v[104:107]
  v_mfma_f32_16x16x32_bf16 v[108:111], v[84:87], v[48:51], v[108:111]
  v_mfma_f32_16x16x32_bf16 v[112:115], v[80:83], v[52:55], v[112:115]
  v_mfma_f32_16x16x32_bf16 v[116:119], v[84:87], v[52:55], v[116:119]
  v_mfma_f32_16x16x32_bf16 v[120:123], v[80:83], v[56:59], v[120:123]
  v_mfma_f32_16x16x32_bf16 v[124:127], v[84:87], v[56:59], v[124:127]
  s_waitcnt lgkmcnt(0)
  v_mfma_f32_16x16x32_bf16 v[96:99], v[88:91], v[48:51], v[96:99]
  v_mfma_f32_16x16x32_bf16 v[100:103], v[92:95], v[48:51], v[100:103]
  v_mfma_f32_16x16x32_bf16 v[104:107], v[88:91], v[52:55], v[104:107]
  v_mfma_f32_16x16x32_bf16 v[108:111], v[92:95], v[52:55], v[108:111]
  v_mfma_f32_16x16x32_bf16 v[112:115], v[88:91], v[56:59], v[112:115]
  v_mfma_f32_16x16x32_bf16 v[116:119], v[92:95], v[56:59], v[116:119]
  v_mfma_f32_16x16x32_bf16 v[120:123], v[88:91], v[60:63], v[120:123]
  v_mfma_f32_16x16x32_bf16 v[124:127], v[92:95], v[60:63], v[124:127]
  s_cmp_eq_u32 s3, 0
  s_nop 0
  s_cbranch_scc0 CV_Q2
  s_mov_b32 s76, 0x40000
CV_Q1:
  v_readfirstlane_b32 s73, v19
  s_nop 0
  s_cmp_ge_u32 s73, 32
  s_cbranch_scc1 CV_Q3
  s_sleep 6
  global_load_dword v19, v214, s[62:63] offset:128 sc1
  s_waitcnt vmcnt(0)
  s_sub_u32 s76, s76, 1
  s_cbranch_scc0 CV_Q1
CV_Q3:
  v_mov_b32 v19, 32
  ds_write_b32 v212, v19 offset:8
CV_Q2:
  s_cmp_eq_u32 s71, 0
  s_cbranch_scc1 CV_EX
  v_swap_b32 v96, v112
  v_swap_b32 v97, v113
  v_swap_b32 v98, v114
  v_swap_b32 v99, v115
  v_swap_b32 v100, v116
  v_swap_b32 v101, v117
  v_swap_b32 v102, v118
  v_swap_b32 v103, v119
  v_swap_b32 v104, v120
  v_swap_b32 v105, v121
  v_swap_b32 v106, v122
  v_swap_b32 v107, v123
  v_swap_b32 v108, v124
  v_swap_b32 v109, v125
  v_swap_b32 v110, v126
  v_swap_b32 v111, v127
CV_EX:
  ds_write_b128 v199, v[112:115] offset:0
  ds_write_b128 v199, v[116:119] offset:1024
  ds_write_b128 v199, v[120:123] offset:2048
  ds_write_b128 v199, v[124:127] offset:3072
  s_waitcnt lgkmcnt(0)
  v_mov_b32 v7, 4
  ds_write_b32 v221, v7
  s_mov_b32 s76, 0x40000
L10:
  ds_read_b32 v7, v222
  s_waitcnt lgkmcnt(0)
  v_readfirstlane_b32 s73, v7
  s_nop 0
  s_cmp_ge_u32 s73, 4
  s_cbranch_scc1 L11
  s_sleep 1
  s_sub_u32 s76, s76, 1
  s_cbranch_scc0 L10
L11:
  ds_read_b128 v[32:35], v200 offset:0
  ds_read_b128 v[36:39], v200 offset:1024
  ds_read_b128 v[40:43], v200 offset:2048
  ds_read_b128 v[44:47], v200 offset:3072
  s_waitcnt lgkmcnt(3)
  v_add_f32 v96, v96, v32
  v_add_f32 v97, v97, v33
  v_add_f32 v98, v98, v34
  v_add_f32 v99, v99, v35
  v_cvt_pk_bf16_f32 v48, v96, v97
  v_min_u32 v48, -2, v48
  v_cvt_pk_bf16_f32 v49, v98, v99
  v_min_u32 v49, -2, v49
  ds_write_b64 v198, v[48:49] offset:0
  s_waitcnt lgkmcnt(3)
  v_add_f32 v100, v100, v36
  v_add_f32 v101, v101, v37
  v_add_f32 v102, v102, v38
  v_add_f32 v103, v103, v39
  v_cvt_pk_bf16_f32 v50, v100, v101
  v_min_u32 v50, -2, v50
  v_cvt_pk_bf16_f32 v51, v102, v103
  v_min_u32 v51, -2, v51
  ds_write_b64 v198, v[50:51] offset:64
  s_waitcnt lgkmcnt(3)
  v_add_f32 v104, v104, v40
  v_add_f32 v105, v105, v41
  v_add_f32 v106, v106, v42
  v_add_f32 v107, v107, v43
  v_cvt_pk_bf16_f32 v52, v104, v105
  v_min_u32 v52, -2, v52
  v_cvt_pk_bf16_f32 v53, v106, v107
  v_min_u32 v53, -2, v53
  ds_write_b64 v198, v[52:53] offset:1024
  s_waitcnt lgkmcnt(3)
  v_add_f32 v108, v108, v44
  v_add_f32 v109, v109, v45
  v_add_f32 v110, v110, v46
  v_add_f32 v111, v111, v47
  v_cvt_pk_bf16_f32 v54, v108, v109
  v_min_u32 v54, -2, v54
  v_cvt_pk_bf16_f32 v55, v110, v111
  v_min_u32 v55, -2, v55
  ds_write_b64 v198, v[54:55] offset:1088
  ds_read_b128 v[56:59], v220
  ds_read_b128 v[60:63], v220 offset:1024
  s_lshl_b32 s73, s70, 12
  s_lshl_b32 s74, s71, 11
  s_add_u32 s73, s73, s74
  s_add_u32 s73, s73, 0xb00000
  v_add_u32 v4, 4, v213
  s_mov_b32 s76, 0x40000
L12:
  ds_read_b32 v5, v4
  s_waitcnt lgkmcnt(0)
  v_readfirstlane_b32 s74, v5
  s_nop 0
  s_cmp_ge_u32 s74, 32
  s_cbranch_scc1 L13
  s_sleep 1
  s_sub_u32 s76, s76, 1
  s_cbranch_scc0 L12
L13:
  s_setprio 3
  buffer_store_dwordx4 v[56:59], v203, s[16:19], s73 offen sc1
  buffer_store_dwordx4 v[60:63], v203, s[16:19], s73 offen offset:1024 sc1
  s_setprio 0
  ds_write_b128 v220, v[128:131] offset:0
  ds_write_b128 v220, v[132:135] offset:1024
  ds_write_b128 v220, v[136:139] offset:2048
  ds_write_b128 v220, v[140:143] offset:3072
  v_mov_b32 v31, 2
  ds_write_b32 v217, v31
  ds_write_b128 v220, v[144:147] offset:4096
  ds_write_b128 v220, v[148:151] offset:5120
  ds_write_b128 v220, v[152:155] offset:6144
  ds_write_b128 v220, v[156:159] offset:7168
  v_mov_b32 v31, 3
  ds_write_b32 v217, v31
  ds_write_b128 v220, v[160:163] offset:8192
  ds_write_b128 v220, v[164:167] offset:9216
  ds_write_b128 v220, v[168:171] offset:10240
  ds_write_b128 v220, v[172:175] offset:11264
  v_mov_b32 v31, 4
  ds_write_b32 v217, v31
  v_add_u32 v4, s30, v203
  s_waitcnt vmcnt(2)
  s_setprio 0
  s_mov_b32 s76, 0x40000
L14:
  ds_read_b32 v5, v223
  s_waitcnt lgkmcnt(0)
  v_readfirstlane_b32 s73, v5
  s_nop 0
  s_cmp_ge_u32 s73, 1
  s_cbranch_scc1 L15
  s_sleep 1
  s_sub_u32 s76, s76, 1
  s_cbranch_scc0 L14
L15:
  s_setprio 0
  ds_write_b128 v4, v[176:179] offset:0
  ds_write_b128 v4, v[180:183] offset:1024
  ds_write_b128 v4, v[184:187] offset:2048
  ds_write_b128 v4, v[188:191] offset:3072
  v_mov_b32 v31, 5
  ds_write_b32 v217, v31
  s_setprio 0
  s_mov_b32 s76, 0x40000
L16:
  ds_read_b32 v5, v223
  s_waitcnt lgkmcnt(0)
  v_readfirstlane_b32 s73, v5
  s_nop 0
  s_cmp_ge_u32 s73, 2
  s_cbranch_scc1 L17
  s_sleep 1
  s_sub_u32 s76, s76, 1
  s_cbranch_scc0 L16
L17:
  s_setprio 0
  ds_write_b128 v4, v[224:227] offset:4096
  ds_write_b128 v4, v[228:231] offset:5120
  ds_write_b128 v4, v[232:235] offset:6144
  ds_write_b128 v4, v[236:239] offset:7168
  v_mov_b32 v31, 6
  ds_write_b32 v217, v31
  s_setprio 0
  s_mov_b32 s76, 0x40000
L18:
  ds_read_b32 v5, v223
  s_waitcnt lgkmcnt(0)
  v_readfirstlane_b32 s73, v5
  s_nop 0
  s_cmp_ge_u32 s73, 3
  s_cbranch_scc1 L19
  s_sleep 1
  s_sub_u32 s76, s76, 1
  s_cbranch_scc0 L18
L19:
  s_setprio 0
  ds_write_b128 v4, v[240:243] offset:8192
  ds_write_b128 v4, v[244:247] offset:9216
  ds_write_b128 v4, v[248:251] offset:10240
  ds_write_b128 v4, v[252:255] offset:11264
  v_mov_b32 v31, 7
  ds_write_b32 v217, v31
  s_setprio 0
  s_cmp_eq_u32 s3, 0
  s_cbranch_scc0 H_END
  v_lshrrev_b32 v4, 3, v1
  v_and_b32 v5, 7, v1
  v_lshlrev_b32 v6, 12, v4
  v_lshl_add_u32 v6, v5, 4, v6
  s_lshl_b32 s73, s68, 18
  s_lshl_b32 s74, s67, 7
  s_add_u32 s73, s73, s74
  s_add_u32 s74, s73, 0xb00000
  v_mul_u32_u24 v4, 192, v4
  v_lshl_add_u32 v4, v5, 4, v4
  v_add_u32 v4, 81920, v4
  s_mov_b32 s76, 0x4000
H_AP:
  s_add_u32 s73, s74, 0
  buffer_load_dwordx4 v[32:35], v6, s[16:19], s73 offen sc1
  s_add_u32 s73, s74, 32768
  buffer_load_dwordx4 v[36:39], v6, s[16:19], s73 offen sc1
  s_add_u32 s73, s74, 65536
  buffer_load_dwordx4 v[40:43], v6, s[16:19], s73 offen sc1
  s_add_u32 s73, s74, 98304
  buffer_load_dwordx4 v[44:47], v6, s[16:19], s73 offen sc1
  s_add_u32 s73, s74, 131072
  buffer_load_dwordx4 v[48:51], v6, s[16:19], s73 offen sc1
  s_add_u32 s73, s74, 163840
  buffer_load_dwordx4 v[52:55], v6, s[16:19], s73 offen sc1
  s_add_u32 s73, s74, 196608
  buffer_load_dwordx4 v[56:59], v6, s[16:19], s73 offen sc1
  s_add_u32 s73, s74, 229376
  buffer_load_dwordx4 v[60:63], v6, s[16:19], s73 offen sc1
  s_waitcnt vmcnt(0)
  v_max3_u32 v64, v32, v33, v34
  v_max3_u32 v65, v35, v36, v37
  v_max3_u32 v66, v38, v39, v40
  v_max3_u32 v67, v41, v42, v43
  v_max3_u32 v68, v44, v45, v46
  v_max3_u32 v69, v47, v48, v49
  v_max3_u32 v70, v50, v51, v52
  v_max3_u32 v71, v53, v54, v55
  v_max3_u32 v72, v56, v57, v58
  v_max3_u32 v73, v59, v60, v61
  v_max3_u32 v64, v64, v62, v63
  v_max3_u32 v74, v64, v65, v66
  v_max3_u32 v75, v67, v68, v69
  v_max3_u32 v76, v70, v71, v72
  v_max3_u32 v74, v74, v75, v76
  v_max_u32 v74, v74, v73
  v_cmp_eq_u32 vcc, -1, v74
  s_cbranch_vccz H_AG
  s_sleep 4
  s_sub_u32 s76, s76, 1
  s_cbranch_scc0 H_AP
H_AG:
  v_xor_b32 v5, 4, v217
  s_mov_b32 s76, 0x40000
L20:
  ds_read_b32 v6, v5
  s_waitcnt lgkmcnt(0)
  v_readfirstlane_b32 s73, v6
  s_nop 0
  s_cmp_ge_u32 s73, 2
  s_cbranch_scc1 L21
  s_sub_u32 s76, s76, 1
  s_cbranch_scc0 L20
L21:
  v_xor_b32 v5, 8, v217
  s_mov_b32 s76, 0x40000
L22:
  ds_read_b32 v6, v5
  s_waitcnt lgkmcnt(0)
  v_readfirstlane_b32 s73, v6
  s_nop 0
  s_cmp_ge_u32 s73, 2
  s_cbranch_scc1 L23
  s_sub_u32 s76, s76, 1
  s_cbranch_scc0 L22
L23:
  v_xor_b32 v5, 12, v217
  s_mov_b32 s76, 0x40000
L24:
  ds_read_b32 v6, v5
  s_waitcnt lgkmcnt(0)
  v_readfirstlane_b32 s73, v6
  s_nop 0
  s_cmp_ge_u32 s73, 2
  s_cbranch_scc1 L25
  s_sub_u32 s76, s76, 1
  s_cbranch_scc0 L24
L25:
  ds_write_b128 v4, v[32:35] offset:0
  ds_write_b128 v4, v[36:39] offset:1536
  ds_write_b128 v4, v[40:43] offset:3072
  ds_write_b128 v4, v[44:47] offset:4608
  ds_write_b128 v4, v[48:51] offset:6144
  ds_write_b128 v4, v[52:55] offset:7680
  ds_write_b128 v4, v[56:59] offset:9216
  ds_write_b128 v4, v[60:63] offset:10752
  s_waitcnt lgkmcnt(0)
  s_barrier
H_END:
  s_endpgm
H_PREP:
  global_load_ushort v10, v2, s[34:35]
  global_load_ushort v11, v2, s[36:37]
  global_load_ushort v12, v2, s[38:39]
  global_load_ushort v13, v2, s[40:41]
  global_load_ushort v14, v2, s[42:43]
  global_load_ushort v15, v2, s[44:45]
  global_load_ushort v16, v3, s[46:47]
  global_load_ushort v17, v3, s[48:49]
  s_mov_b32 s16, s64
  s_mov_b32 s17, s65
  s_mov_b32 s18, 0x1000000
  s_mov_b32 s19, 0x20000
  s_cmp_eq_u32 s69, 0
  s_mov_b32 s72, 98304
  s_cselect_b32 s72, 131072, s72
  s_add_u32 s75, s72, 2560
  s_add_u32 s78, s72, 31232
  s_lshl_b32 s73, s3, 2
  s_add_u32 s73, s73, 163824
  v_mov_b32 v221, s73
  v_xor_b32 v222, 4, v221
  v_mov_b32 v7, 0
  ds_write_b32 v221, v7
  v_subrev_u32 v4, 16, v221
  ds_write_b32 v4, v7
  v_mov_b32 v212, 163792
  ds_write_b32 v212, v7
  ds_write_b32 v212, v7 offset:4
  ds_write_b32 v212, v7 offset:8
  v_mov_b32 v213, 163796
  v_mov_b32 v214, 0
  v_subrev_u32 v217, 48, v221
  ds_write_b32 v217, v7
  v_subrev_u32 v223, 64, v221
  ds_write_b32 v223, v7
  v_bfe_u32 v4, v1, 4, 1
  v_lshlrev_b32 v219, 2, v4
  v_and_b32 v5, 7, v1
  v_xor_b32 v219, v219, v5
  v_lshlrev_b32 v219, 4, v219
  v_lshrrev_b32 v5, 3, v1
  v_lshl_add_u32 v219, v5, 10, v219
  v_xor_b32 v218, 32, v219
  s_mul_i32 s29, s3, 458752
  s_lshl_b32 s30, s68, 7
  s_add_u32 s29, s29, s30
  s_mul_i32 s30, s3, 4096
  s_add_u32 s30, s30, 131072
  s_mov_b32 s24, s56
  s_mov_b32 s25, s57
  s_mov_b32 s26, 0x1c0000
  s_mov_b32 s27, 0x20000
  s_waitcnt lgkmcnt(0)
  s_barrier
  v_and_b32 v2, 15, v1
  v_lshrrev_b32 v3, 4, v1
  v_lshrrev_b32 v4, 2, v1
  v_mul_u32_u24 v4, 112, v4
  v_and_b32 v5, 3, v1
  v_lshl_add_u32 v4, v5, 3, v4
  v_add_u32 v206, s75, v4
  s_lshl_b32 s73, s71, 5
  s_add_u32 s73, s73, 48
  v_add_u32 v207, s73, v206
  v_mov_b32 v49, 0
  v_mov_b32 v50, 0
  v_mov_b32 v51, 0
  v_mov_b32 v52, 0
  v_mov_b32 v53, 0
  v_mov_b32 v54, 0
  v_mov_b32 v55, 0
  v_lshl_add_u32 v6, s71, 4, v2
  v_lshlrev_b32 v7, 3, v6
  v_lshl_add_u32 v7, v3, 2, v7
  v_lshlrev_b32 v8, 2, v6
  v_add_u32 v8, 256, v8
  v_cmp_eq_u32 s[20:21], 2, v3
  s_nop 1
  v_cndmask_b32 v7, v7, v8, s[20:21]
  v_lshlrev_b32 v8, 1, v6
  v_add_u32 v8, 384, v8
  v_cmp_eq_u32 s[20:21], 3, v3
  s_nop 1
  v_cndmask_b32 v7, v7, v8, s[20:21]
  v_cndmask_b32 v8, 2, 64, s[20:21]
  v_add_u32 v8, v7, v8
  v_lshl_add_u32 v208, v7, 1, s78
  v_lshl_add_u32 v209, v8, 1, s78
  v_lshl_add_u32 v9, v3, 7, v6
  v_lshl_add_u32 v210, v9, 1, s78
  v_lshl_add_u32 v6, s71, 6, v1
  v_mul_u32_u24 v211, 112, v6
  v_add_u32 v211, s75, v211
  v_cmp_eq_u32 s[22:23], 0, v6
  v_lshlrev_b32 v203, 4, v1
  s_mul_i32 s73, s71, 6272
  s_add_u32 s73, s73, s72
  v_min_u32 v4, 55, v1
  v_lshrrev_b32 v192, 3, v4
  v_lshl_add_u32 v192, v192, 1, v4
  v_lshl_add_u32 v192, v192, 4, s73
  s_mul_i32 s73, s71, 8832
  s_add_u32 s73, s73, s72
  v_min_u32 v193, 6, v1
  v_lshl_add_u32 v193, v193, 4, s73
  v_mov_b32 v194, s72
  s_lshl_b32 s73, s71, 7
  v_add_u32 v4, s73, v1
  v_lshrrev_b32 v195, 3, v4
  v_lshl_add_u32 v195, v195, 1, v4
  v_lshl_add_u32 v195, v195, 4, s72
  v_add_u32 v4, 1, v4
  v_lshrrev_b32 v196, 3, v4
  v_lshl_add_u32 v196, v196, 1, v4
  v_lshl_add_u32 v196, v196, 4, s72
  s_lshl_b32 s73, s71, 11
  s_add_u32 s73, s73, s72
  v_add_u32 v197, s73, v203
  v_and_b32 v4, 3, v1
  v_mul_u32_u24 v4, 4416, v4
  v_bfe_u32 v5, v1, 2, 2
  v_lshrrev_b32 v6, 4, v1
  v_sub_u32 v5, v5, v6
  v_lshl_add_u32 v4, v5, 4, v4
  s_lshl_b32 s73, s71, 9
  s_add_u32 s73, s73, s72
  s_add_u32 s73, s73, 48
  v_add_u32 v201, s73, v4
  v_and_b32 v4, 1, v1
  v_mul_u32_u24 v7, 6272, v4
  v_bfe_u32 v5, v1, 1, 3
  v_mul_u32_u24 v8, 160, v5
  v_add_u32 v7, v7, v8
  v_lshl_add_u32 v7, v6, 4, v7
  s_mul_i32 s73, s71, 640
  s_sub_u32 s73, s72, s73
  s_add_u32 s73, s73, 18304
  v_add_u32 v202, s73, v7
  v_lshlrev_b32 v5, 7, v5
  v_lshl_add_u32 v5, v4, 3, v5
  v_lshl_add_u32 v5, v6, 4, v5
  s_mul_i32 s73, s71, 12288
  s_add_u32 s73, s73, s72
  v_add_u32 v198, s73, v5
  v_add_u32 v220, s73, v203
  s_lshl_b32 s73, s3, 12
  s_add_u32 s73, s73, 81920
  v_add_u32 v199, s73, v203
  v_xor_b32 v200, 0x1000, v199
  s_lshl_b32 s73, s71, 10
  v_lshl_add_u32 v46, v1, 3, s73
  v_lshl_add_u32 v47, v46, 1, s78
  v_cvt_f32_u32 v46, v46
  s_sub_u32 s74, s78, 34048
  s_add_u32 s73, s78, 256
  v_mov_b32 v57, s73
  v_add_f32 v224, 0xc0400000, v46
  v_cvt_pk_bf16_f32 v224, v224, 0
  v_lshl_add_u32 v224, v224, 1, s74
  v_add_u32 v56, -6, v47
  v_med3_i32 v224, v224, v56, v57
  v_add_f32 v225, 0xc0000000, v46
  v_cvt_pk_bf16_f32 v225, v225, 0
  v_lshl_add_u32 v225, v225, 1, s74
  v_add_u32 v56, -4, v47
  v_med3_i32 v225, v225, v56, v57
  v_add_f32 v226, 0xbf800000, v46
  v_cvt_pk_bf16_f32 v226, v226, 0
  v_lshl_add_u32 v226, v226, 1, s74
  v_add_u32 v56, -2, v47
  v_med3_i32 v226, v226, v56, v57
  v_add_f32 v227, 0x0, v46
  v_cvt_pk_bf16_f32 v227, v227, 0
  v_lshl_add_u32 v227, v227, 1, s74
  v_add_u32 v56, 0, v47
  v_med3_i32 v227, v227, v56, v57
  v_add_f32 v228, 0x3f800000, v46
  v_cvt_pk_bf16_f32 v228, v228, 0
  v_lshl_add_u32 v228, v228, 1, s74
  v_add_u32 v56, 2, v47
  v_med3_i32 v228, v228, v56, v57
  v_add_f32 v229, 0x40000000, v46
  v_cvt_pk_bf16_f32 v229, v229, 0
  v_lshl_add_u32 v229, v229, 1, s74
  v_add_u32 v56, 4, v47
  v_med3_i32 v229, v229, v56, v57
  v_add_f32 v230, 0x40400000, v46
  v_cvt_pk_bf16_f32 v230, v230, 0
  v_lshl_add_u32 v230, v230, 1, s74
  v_add_u32 v56, 6, v47
  v_med3_i32 v230, v230, v56, v57
  v_add_f32 v231, 0x40800000, v46
  v_cvt_pk_bf16_f32 v231, v231, 0
  v_lshl_add_u32 v231, v231, 1, s74
  v_add_u32 v56, 8, v47
  v_med3_i32 v231, v231, v56, v57
  v_add_f32 v232, 0x40a00000, v46
  v_cvt_pk_bf16_f32 v232, v232, 0
  v_lshl_add_u32 v232, v232, 1, s74
  v_add_u32 v56, 10, v47
  v_med3_i32 v232, v232, v56, v57
  v_add_f32 v233, 0x40c00000, v46
  v_cvt_pk_bf16_f32 v233, v233, 0
  v_lshl_add_u32 v233, v233, 1, s74
  v_add_u32 v56, 12, v47
  v_med3_i32 v233, v233, v56, v57
  v_add_f32 v234, 0x40e00000, v46
  v_cvt_pk_bf16_f32 v234, v234, 0
  v_lshl_add_u32 v234, v234, 1, s74
  v_add_u32 v56, 14, v47
  v_med3_i32 v234, v234, v56, v57
  v_add_f32 v235, 0x43fe8000, v46
  v_cvt_pk_bf16_f32 v235, v235, 0
  v_lshl_add_u32 v235, v235, 1, s74
  v_add_f32 v236, 0x43ff0000, v46
  v_cvt_pk_bf16_f32 v236, v236, 0
  v_lshl_add_u32 v236, v236, 1, s74
  v_add_f32 v237, 0x43ff8000, v46
  v_cvt_pk_bf16_f32 v237, v237, 0
  v_lshl_add_u32 v237, v237, 1, s74
  v_add_f32 v238, 0x44000000, v46
  v_cvt_pk_bf16_f32 v238, v238, 0
  v_lshl_add_u32 v238, v238, 1, s74
  v_add_f32 v239, 0x44004000, v46
  v_cvt_pk_bf16_f32 v239, v239, 0
  v_lshl_add_u32 v239, v239, 1, s74
  v_add_f32 v240, 0x44008000, v46
  v_cvt_pk_bf16_f32 v240, v240, 0
  v_lshl_add_u32 v240, v240, 1, s74
  v_add_f32 v241, 0x4400c000, v46
  v_cvt_pk_bf16_f32 v241, v241, 0
  v_lshl_add_u32 v241, v241, 1, s74
  v_add_f32 v242, 0x44010000, v46
  v_cvt_pk_bf16_f32 v242, v242, 0
  v_lshl_add_u32 v242, v242, 1, s74
  v_add_f32 v243, 0x44014000, v46
  v_cvt_pk_bf16_f32 v243, v243, 0
  v_lshl_add_u32 v243, v243, 1, s74
  v_add_f32 v244, 0x44018000, v46
  v_cvt_pk_bf16_f32 v244, v244, 0
  v_lshl_add_u32 v244, v244, 1, s74
  v_add_f32 v245, 0x4401c000, v46
  v_cvt_pk_bf16_f32 v245, v245, 0
  v_lshl_add_u32 v245, v245, 1, s74
  s_waitcnt vmcnt(0)
  v_lshlrev_b32 v10, 16, v10
  v_lshlrev_b32 v11, 16, v11
  v_lshlrev_b32 v12, 16, v12
  v_lshlrev_b32 v13, 16, v13
  v_lshlrev_b32 v14, 16, v14
  v_lshlrev_b32 v15, 16, v15
  v_lshlrev_b32 v16, 16, v16
  v_lshlrev_b32 v17, 16, v17
  v_cndmask_b32 v48, 0, v17, s[22:23]
  v_mul_f32 v16, 0x3fb8aa3b, v16
  v_exp_f32 v16, v16
  s_nop 0
  v_cvt_pk_bf16_f32 v16, v16, v16
  v_lshlrev_b32 v16, 16, v16
  v_mul_f32 v10, v16, v10
  v_mul_f32 v11, v16, v11
  v_mul_f32 v10, 0x3fb8aa3b, v10
  v_mul_f32 v11, 0x3e22f983, v11
  v_mul_f32 v12, v16, v12
  v_mul_f32 v13, v16, v13
  v_mul_f32 v20, v15, v13
  v_mul_f32 v21, v15, v12
  v_fma_f32 v19, v14, v13, v21
  v_fma_f32 v18, v14, v12, -v20
  v_mul_f32 v20, 0x41000000, v10
  v_mul_f32 v21, 0x41000000, v11
  v_exp_f32 v20, v20
  v_fract_f32 v21, v21
  v_cos_f32 v24, v21
  v_sin_f32 v25, v21
  v_mul_f32 v24, v20, v24
  v_mul_f32 v25, v20, v25
  v_mul_f32 v20, 0x3f800000, v10
  v_mul_f32 v21, 0x3f800000, v11
  v_exp_f32 v20, v20
  v_fract_f32 v21, v21
  v_cos_f32 v22, v21
  v_sin_f32 v23, v21
  v_mul_f32 v22, v20, v22
  v_mul_f32 v23, v20, v23
  v_mul_f32 v20, 0x43800000, v10
  v_mul_f32 v21, 0x43800000, v11
  v_exp_f32 v20, v20
  v_fract_f32 v21, v21
  v_cos_f32 v26, v21
  v_sin_f32 v27, v21
  v_mul_f32 v26, v20, v26
  v_mul_f32 v27, v20, v27
  v_cvt_pk_bf16_f32 v76, 1.0, v24
  v_mov_b32 v128, v18
  v_cvt_pk_bf16_f32 v108, 0, v25
  v_mov_b32 v129, v19
  v_mul_f32 v44, v25, v25
  v_mul_f32 v20, v129, v23
  v_mul_f32 v45, v25, v24
  v_mul_f32 v21, v129, v22
  v_fma_f32 v41, v24, v25, v45
  v_fma_f32 v131, v128, v23, v21
  v_fma_f32 v40, v24, v24, -v44
  v_fma_f32 v130, v128, v22, -v20
  v_mul_f32 v44, v41, v25
  v_cvt_pk_bf16_f32 v64, v128, v130
  v_mul_f32 v45, v41, v24
  v_cvt_pk_bf16_f32 v96, -v129, -v131
  v_fma_f32 v43, v40, v25, v45
  v_mul_f32 v20, v131, v23
  v_fma_f32 v42, v40, v24, -v44
  v_mul_f32 v21, v131, v22
  v_cvt_pk_bf16_f32 v77, v40, v42
  v_fma_f32 v133, v130, v23, v21
  v_cvt_pk_bf16_f32 v109, v41, v43
  v_fma_f32 v132, v130, v22, -v20
  v_mul_f32 v44, v43, v25
  v_mul_f32 v20, v133, v23
  v_mul_f32 v45, v43, v24
  v_mul_f32 v21, v133, v22
  v_fma_f32 v41, v42, v25, v45
  v_fma_f32 v135, v132, v23, v21
  v_fma_f32 v40, v42, v24, -v44
  v_fma_f32 v134, v132, v22, -v20
  v_mul_f32 v44, v41, v25
  v_cvt_pk_bf16_f32 v65, v132, v134
  v_mul_f32 v45, v41, v24
  v_cvt_pk_bf16_f32 v97, -v133, -v135
  v_fma_f32 v43, v40, v25, v45
  v_mul_f32 v20, v135, v23
  v_fma_f32 v42, v40, v24, -v44
  v_mul_f32 v21, v135, v22
  v_cvt_pk_bf16_f32 v78, v40, v42
  v_fma_f32 v137, v134, v23, v21
  v_cvt_pk_bf16_f32 v110, v41, v43
  v_fma_f32 v136, v134, v22, -v20
  v_mul_f32 v44, v43, v25
  v_mul_f32 v20, v137, v23
  v_mul_f32 v45, v43, v24
  v_mul_f32 v21, v137, v22
  v_fma_f32 v41, v42, v25, v45
  v_fma_f32 v139, v136, v23, v21
  v_fma_f32 v40, v42, v24, -v44
  v_fma_f32 v138, v136, v22, -v20
  v_mul_f32 v44, v41, v25
  v_cvt_pk_bf16_f32 v66, v136, v138
  v_mul_f32 v45, v41, v24
  v_cvt_pk_bf16_f32 v98, -v137, -v139
  v_fma_f32 v43, v40, v25, v45
  v_mul_f32 v20, v139, v23
  v_fma_f32 v42, v40, v24, -v44
  v_mul_f32 v21, v139, v22
  v_cvt_pk_bf16_f32 v79, v40, v42
  v_fma_f32 v141, v138, v23, v21
  v_cvt_pk_bf16_f32 v111, v41, v43
  v_fma_f32 v140, v138, v22, -v20
  v_mul_f32 v44, v43, v25
  v_mul_f32 v20, v141, v23
  v_mul_f32 v45, v43, v24
  v_mul_f32 v21, v141, v22
  v_fma_f32 v41, v42, v25, v45
  v_fma_f32 v143, v140, v23, v21
  v_fma_f32 v40, v42, v24, -v44
  v_fma_f32 v142, v140, v22, -v20
  v_mul_f32 v44, v41, v25
  v_cvt_pk_bf16_f32 v67, v140, v142
  v_mul_f32 v45, v41, v24
  v_cvt_pk_bf16_f32 v99, -v141, -v143
  v_fma_f32 v43, v40, v25, v45
  v_mul_f32 v20, v129, v27
  v_fma_f32 v42, v40, v24, -v44
  v_mul_f32 v21, v129, v26
  v_cvt_pk_bf16_f32 v80, v40, v42
  v_fma_f32 v145, v128, v27, v21
  v_cvt_pk_bf16_f32 v112, v41, v43
  v_fma_f32 v144, v128, v26, -v20
  v_mul_f32 v44, v43, v25
  v_mul_f32 v20, v133, v27
  v_mul_f32 v45, v43, v24
  v_mul_f32 v21, v133, v26
  v_fma_f32 v41, v42, v25, v45
  v_fma_f32 v147, v132, v27, v21
  v_fma_f32 v40, v42, v24, -v44
  v_fma_f32 v146, v132, v26, -v20
  v_mul_f32 v44, v41, v25
  v_cvt_pk_bf16_f32 v68, v144, v146
  v_mul_f32 v45, v41, v24
  v_cvt_pk_bf16_f32 v100, -v145, -v147
  v_fma_f32 v43, v40, v25, v45
  v_mul_f32 v20, v137, v27
  v_fma_f32 v42, v40, v24, -v44
  v_mul_f32 v21, v137, v26
  v_cvt_pk_bf16_f32 v81, v40, v42
  v_fma_f32 v149, v136, v27, v21
  v_cvt_pk_bf16_f32 v113, v41, v43
  v_fma_f32 v148, v136, v26, -v20
  v_mul_f32 v44, v43, v25
  v_mul_f32 v20, v141, v27
  v_mul_f32 v45, v43, v24
  v_mul_f32 v21, v141, v26
  v_fma_f32 v41, v42, v25, v45
  v_fma_f32 v151, v140, v27, v21
  v_fma_f32 v40, v42, v24, -v44
  v_fma_f32 v150, v140, v26, -v20
  v_mul_f32 v44, v41, v25
  v_cvt_pk_bf16_f32 v69, v148, v150
  v_mul_f32 v45, v41, v24
  v_cvt_pk_bf16_f32 v101, -v149, -v151
  v_fma_f32 v43, v40, v25, v45
  v_mul_f32 v20, v145, v27
  v_fma_f32 v42, v40, v24, -v44
  v_mul_f32 v21, v145, v26
  v_cvt_pk_bf16_f32 v82, v40, v42
  v_fma_f32 v153, v144, v27, v21
  v_cvt_pk_bf16_f32 v114, v41, v43
  v_fma_f32 v152, v144, v26, -v20
  v_mul_f32 v44, v43, v25
  v_mul_f32 v20, v149, v27
  v_mul_f32 v45, v43, v24
  v_mul_f32 v21, v149, v26
  v_fma_f32 v41, v42, v25, v45
  v_fma_f32 v155, v148, v27, v21
  v_fma_f32 v40, v42, v24, -v44
  v_fma_f32 v154, v148, v26, -v20
  v_mul_f32 v44, v41, v25
  v_cvt_pk_bf16_f32 v70, v152, v154
  v_mul_f32 v45, v41, v24
  v_cvt_pk_bf16_f32 v102, -v153, -v155
  v_fma_f32 v43, v40, v25, v45
  v_mul_f32 v20, v153, v27
  v_fma_f32 v42, v40, v24, -v44
  v_mul_f32 v21, v153, v26
  v_cvt_pk_bf16_f32 v83, v40, v42
  v_fma_f32 v157, v152, v27, v21
  v_cvt_pk_bf16_f32 v115, v41, v43
  v_fma_f32 v156, v152, v26, -v20
  v_mul_f32 v44, v43, v25
  v_mul_f32 v20, v155, v27
  v_mul_f32 v45, v43, v24
  v_mul_f32 v21, v155, v26
  v_fma_f32 v41, v42, v25, v45
  v_fma_f32 v159, v154, v27, v21
  v_fma_f32 v40, v42, v24, -v44
  v_fma_f32 v158, v154, v26, -v20
  v_mul_f32 v44, v41, v25
  v_cvt_pk_bf16_f32 v71, v156, v158
  v_mul_f32 v45, v41, v24
  v_cvt_pk_bf16_f32 v103, -v157, -v159
  v_fma_f32 v43, v40, v25, v45
  v_mul_f32 v20, v157, v27
  v_fma_f32 v42, v40, v24, -v44
  v_mul_f32 v21, v157, v26
  v_cvt_pk_bf16_f32 v84, v40, v42
  v_fma_f32 v161, v156, v27, v21
  v_cvt_pk_bf16_f32 v116, v41, v43
  v_fma_f32 v160, v156, v26, -v20
  v_mul_f32 v44, v43, v25
  v_mul_f32 v20, v161, v27
  v_mul_f32 v45, v43, v24
  v_mul_f32 v21, v161, v26
  v_fma_f32 v41, v42, v25, v45
  v_fma_f32 v163, v160, v27, v21
  v_fma_f32 v40, v42, v24, -v44
  v_fma_f32 v162, v160, v26, -v20
  v_mul_f32 v44, v41, v25
  v_cvt_pk_bf16_f32 v72, v160, v162
  v_mul_f32 v45, v41, v24
  v_cvt_pk_bf16_f32 v104, -v161, -v163
  v_fma_f32 v43, v40, v25, v45
  v_mul_f32 v20, v163, v27
  v_fma_f32 v42, v40, v24, -v44
  v_mul_f32 v21, v163, v26
  v_cvt_pk_bf16_f32 v85, v40, v42
  v_fma_f32 v165, v162, v27, v21
  v_cvt_pk_bf16_f32 v117, v41, v43
  v_fma_f32 v164, v162, v26, -v20
  v_mul_f32 v44, v43, v25
  v_mul_f32 v20, v165, v27
  v_mul_f32 v45, v43, v24
  v_mul_f32 v21, v165, v26
  v_fma_f32 v41, v42, v25, v45
  v_fma_f32 v167, v164, v27, v21
  v_fma_f32 v40, v42, v24, -v44
  v_fma_f32 v166, v164, v26, -v20
  v_mul_f32 v44, v41, v25
  v_cvt_pk_bf16_f32 v73, v164, v166
  v_mul_f32 v45, v41, v24
  v_cvt_pk_bf16_f32 v105, -v165, -v167
  v_fma_f32 v43, v40, v25, v45
  v_mul_f32 v20, v167, v27
  v_fma_f32 v42, v40, v24, -v44
  v_mul_f32 v21, v167, v26
  v_cvt_pk_bf16_f32 v86, v40, v42
  v_fma_f32 v169, v166, v27, v21
  v_cvt_pk_bf16_f32 v118, v41, v43
  v_fma_f32 v168, v166, v26, -v20
  v_mul_f32 v44, v43, v25
  v_cvt_pk_bf16_f32 v74, v168, v168
  v_mul_f32 v45, v43, v24
  v_cvt_pk_bf16_f32 v106, -v169, -v169
  v_fma_f32 v41, v42, v25, v45
  v_fma_f32 v40, v42, v24, -v44
  v_mul_f32 v44, v41, v25
  v_mul_f32 v45, v41, v24
  v_fma_f32 v43, v40, v25, v45
  v_fma_f32 v42, v40, v24, -v44
  v_cvt_pk_bf16_f32 v87, v40, v42
  v_cvt_pk_bf16_f32 v119, v41, v43
  v_mul_f32 v44, v43, v25
  v_mul_f32 v45, v43, v24
  v_fma_f32 v41, v42, v25, v45
  v_fma_f32 v40, v42, v24, -v44
  v_mul_f32 v44, v41, v25
  v_mul_f32 v45, v41, v24
  v_fma_f32 v43, v40, v25, v45
  v_fma_f32 v42, v40, v24, -v44
  v_cvt_pk_bf16_f32 v88, v40, v42
  v_cvt_pk_bf16_f32 v120, v41, v43
  v_mul_f32 v44, v43, v25
  v_mul_f32 v45, v43, v24
  v_fma_f32 v41, v42, v25, v45
  v_fma_f32 v40, v42, v24, -v44
  v_mul_f32 v44, v41, v25
  v_mul_f32 v45, v41, v24
  v_fma_f32 v43, v40, v25, v45
  v_fma_f32 v42, v40, v24, -v44
  v_cvt_pk_bf16_f32 v89, v40, v42
  v_cvt_pk_bf16_f32 v121, v41, v43
  v_mul_f32 v44, v43, v25
  v_mul_f32 v45, v43, v24
  v_fma_f32 v41, v42, v25, v45
  v_fma_f32 v40, v42, v24, -v44
  v_mul_f32 v44, v41, v25
  v_mul_f32 v45, v41, v24
  v_fma_f32 v43, v40, v25, v45
  v_fma_f32 v42, v40, v24, -v44
  v_cvt_pk_bf16_f32 v90, v40, v42
  v_cvt_pk_bf16_f32 v122, v41, v43
  v_mul_f32 v44, v43, v25
  v_mul_f32 v45, v43, v24
  v_fma_f32 v41, v42, v25, v45
  v_fma_f32 v40, v42, v24, -v44
  v_mul_f32 v44, v41, v25
  v_mul_f32 v45, v41, v24
  v_fma_f32 v43, v40, v25, v45
  v_fma_f32 v42, v40, v24, -v44
  v_cvt_pk_bf16_f32 v91, v40, v42
  v_cvt_pk_bf16_f32 v123, v41, v43
  ds_write_b128 v211, v[64:67] offset:0
  ds_write_b128 v211, v[68:71] offset:16
  ds_write_b128 v211, v[72:75] offset:32
  ds_write_b128 v211, v[76:79] offset:48
  ds_write_b128 v211, v[80:83] offset:64
  ds_write_b128 v211, v[84:87] offset:80
  ds_write_b128 v211, v[88:91] offset:96
  ds_write_b128 v211, v[96:99] offset:14336
  ds_write_b128 v211, v[100:103] offset:14352
  ds_write_b128 v211, v[104:107] offset:14368
  ds_write_b128 v211, v[108:111] offset:14384
  ds_write_b128 v211, v[112:115] offset:14400
  ds_write_b128 v211, v[116:119] offset:14416
  ds_write_b128 v211, v[120:123] offset:14432
  v_mov_b32 v19, 0
  s_waitcnt lgkmcnt(0)
  v_mov_b32 v7, 1
  ds_write_b32 v221, v7
  s_mov_b32 s76, 0x40000
L26:
  ds_read_b32 v7, v222
  s_waitcnt lgkmcnt(0)
  v_readfirstlane_b32 s73, v7
  s_nop 0
  s_cmp_ge_u32 s73, 1
  s_cbranch_scc1 L27
  s_sleep 1
  s_sub_u32 s76, s76, 1
  s_cbranch_scc0 L26
L27:
  ds_read_b64_tr_b16 v[64:65], v206 offset:0
  ds_read_b64_tr_b16 v[66:67], v206 offset:14336
  ds_read_b64_tr_b16 v[68:69], v206 offset:32
  ds_read_b64_tr_b16 v[70:71], v206 offset:14368
  ds_read_b64_tr_b16 v[72:73], v207 offset:0
  ds_read_b64_tr_b16 v[74:75], v207 offset:14336
  ds_read_b64_tr_b16 v[76:77], v206 offset:1792
  ds_read_b64_tr_b16 v[78:79], v206 offset:16128
  ds_read_b64_tr_b16 v[80:81], v206 offset:1824
  ds_read_b64_tr_b16 v[82:83], v206 offset:16160
  ds_read_b64_tr_b16 v[84:85], v207 offset:1792
  ds_read_b64_tr_b16 v[86:87], v207 offset:16128
  ds_read_b64_tr_b16 v[88:89], v206 offset:3584
  ds_read_b64_tr_b16 v[90:91], v206 offset:17920
  ds_read_b64_tr_b16 v[92:93], v206 offset:3616
  ds_read_b64_tr_b16 v[94:95], v206 offset:17952
  ds_read_b64_tr_b16 v[96:97], v207 offset:3584
  ds_read_b64_tr_b16 v[98:99], v207 offset:17920
  s_waitcnt lgkmcnt(12)
  v_mfma_f32_16x16x32_bf16 v[48:51], v[64:67], v[72:75], v[48:51]
  v_mfma_f32_16x16x32_bf16 v[52:55], v[68:71], v[72:75], v[52:55]
  ds_read_b64_tr_b16 v[100:101], v206 offset:5376
  ds_read_b64_tr_b16 v[102:103], v206 offset:19712
  ds_read_b64_tr_b16 v[104:105], v206 offset:5408
  ds_read_b64_tr_b16 v[106:107], v206 offset:19744
  ds_read_b64_tr_b16 v[108:109], v207 offset:5376
  ds_read_b64_tr_b16 v[110:111], v207 offset:19712
  s_waitcnt lgkmcnt(12)
  v_mfma_f32_16x16x32_bf16 v[48:51], v[76:79], v[84:87], v[48:51]
  v_mfma_f32_16x16x32_bf16 v[52:55], v[80:83], v[84:87], v[52:55]
  ds_read_b64_tr_b16 v[112:113], v206 offset:7168
  ds_read_b64_tr_b16 v[114:115], v206 offset:21504
  ds_read_b64_tr_b16 v[116:117], v206 offset:7200
  ds_read_b64_tr_b16 v[118:119], v206 offset:21536
  ds_read_b64_tr_b16 v[120:121], v207 offset:7168
  ds_read_b64_tr_b16 v[122:123], v207 offset:21504
  s_waitcnt lgkmcnt(12)
  v_mfma_f32_16x16x32_bf16 v[48:51], v[88:91], v[96:99], v[48:51]
  v_mfma_f32_16x16x32_bf16 v[52:55], v[92:95], v[96:99], v[52:55]
  ds_read_b64_tr_b16 v[64:65], v206 offset:8960
  ds_read_b64_tr_b16 v[66:67], v206 offset:23296
  ds_read_b64_tr_b16 v[68:69], v206 offset:8992
  ds_read_b64_tr_b16 v[70:71], v206 offset:23328
  ds_read_b64_tr_b16 v[72:73], v207 offset:8960
  ds_read_b64_tr_b16 v[74:75], v207 offset:23296
  s_waitcnt lgkmcnt(12)
  v_mfma_f32_16x16x32_bf16 v[48:51], v[100:103], v[108:111], v[48:51]
  v_mfma_f32_16x16x32_bf16 v[52:55], v[104:107], v[108:111], v[52:55]
  ds_read_b64_tr_b16 v[76:77], v206 offset:10752
  ds_read_b64_tr_b16 v[78:79], v206 offset:25088
  ds_read_b64_tr_b16 v[80:81], v206 offset:10784
  ds_read_b64_tr_b16 v[82:83], v206 offset:25120
  ds_read_b64_tr_b16 v[84:85], v207 offset:10752
  ds_read_b64_tr_b16 v[86:87], v207 offset:25088
  s_waitcnt lgkmcnt(12)
  v_mfma_f32_16x16x32_bf16 v[48:51], v[112:115], v[120:123], v[48:51]
  v_mfma_f32_16x16x32_bf16 v[52:55], v[116:119], v[120:123], v[52:55]
  ds_read_b64_tr_b16 v[88:89], v206 offset:12544
  ds_read_b64_tr_b16 v[90:91], v206 offset:26880
  ds_read_b64_tr_b16 v[92:93], v206 offset:12576
  ds_read_b64_tr_b16 v[94:95], v206 offset:26912
  ds_read_b64_tr_b16 v[96:97], v207 offset:12544
  ds_read_b64_tr_b16 v[98:99], v207 offset:26880
  s_waitcnt lgkmcnt(12)
  v_mfma_f32_16x16x32_bf16 v[48:51], v[64:67], v[72:75], v[48:51]
  v_mfma_f32_16x16x32_bf16 v[52:55], v[68:71], v[72:75], v[52:55]
  s_waitcnt lgkmcnt(6)
  v_mfma_f32_16x16x32_bf16 v[48:51], v[76:79], v[84:87], v[48:51]
  v_mfma_f32_16x16x32_bf16 v[52:55], v[80:83], v[84:87], v[52:55]
  s_waitcnt lgkmcnt(0)
  v_mfma_f32_16x16x32_bf16 v[48:51], v[88:91], v[96:99], v[48:51]
  v_mfma_f32_16x16x32_bf16 v[52:55], v[92:95], v[96:99], v[52:55]
  s_nop 6
  v_cvt_pk_bf16_f32 v48, v48, v49
  v_cvt_pk_bf16_f32 v50, v50, v51
  v_cvt_pk_bf16_f32 v52, v52, v53
  v_cvt_pk_bf16_f32 v54, v54, v55
  ds_write_b32 v208, v48
  ds_write_b32 v209, v50
  s_mov_b32 exec_hi, 0
  ds_write_b16 v210, v52 offset:1024
  s_mov_b32 exec_lo, 0xffff
  ds_write_b16_d16_hi v210, v52 offset:1088
  ds_write_b16 v210, v54 offset:1152
  ds_write_b16_d16_hi v210, v54 offset:1216
  s_mov_b64 exec, -1
  s_add_u32 s73, s29, 221184
  buffer_load_dwordx4 v[164:167], v218, s[24:27], s73 offen
  s_add_u32 s73, s29, 245760
  buffer_load_dwordx4 v[168:171], v219, s[24:27], s73 offen
  s_add_u32 s73, s29, 253952
  buffer_load_dwordx4 v[172:175], v218, s[24:27], s73 offen
  s_add_u32 s73, s29, 278528
  buffer_load_dwordx4 v[176:179], v219, s[24:27], s73 offen
  s_add_u32 s73, s29, 286720
  buffer_load_dwordx4 v[180:183], v218, s[24:27], s73 offen
  s_add_u32 s73, s29, 311296
  buffer_load_dwordx4 v[184:187], v219, s[24:27], s73 offen
  s_add_u32 s73, s29, 319488
  buffer_load_dwordx4 v[188:191], v218, s[24:27], s73 offen
  s_waitcnt lgkmcnt(0)
  v_mov_b32 v7, 2
  ds_write_b32 v221, v7
  s_mov_b32 s76, 0x40000
L28:
  ds_read_b32 v7, v222
  s_waitcnt lgkmcnt(0)
  v_readfirstlane_b32 s73, v7
  s_nop 0
  s_cmp_ge_u32 s73, 2
  s_cbranch_scc1 L29
  s_sleep 1
  s_sub_u32 s76, s76, 1
  s_cbranch_scc0 L28
L29:
  ds_read_u16 v64, v224
  ds_read_u16 v65, v225
  ds_read_u16 v66, v226
  ds_read_u16 v67, v227
  ds_read_u16 v68, v228
  ds_read_u16 v69, v229
  ds_read_u16 v70, v230
  ds_read_u16 v71, v231
  ds_read_u16 v72, v232
  ds_read_u16 v73, v233
  ds_read_u16 v74, v234
  ds_read_u16 v75, v235
  ds_read_u16 v76, v236
  ds_read_u16 v77, v237
  ds_read_u16 v78, v238
  ds_read_u16 v79, v239
  ds_read_u16 v80, v240
  ds_read_u16 v81, v241
  ds_read_u16 v82, v242
  ds_read_u16 v83, v243
  ds_read_u16 v84, v244
  ds_read_u16 v85, v245
  s_waitcnt lgkmcnt(0)
  v_cndmask_b32 v64, v64, 0, s[22:23]
  v_cndmask_b32 v65, v65, 0, s[22:23]
  v_cndmask_b32 v66, v66, 0, s[22:23]
  v_lshl_or_b32 v96, v70, 16, v71
  v_lshl_or_b32 v97, v68, 16, v69
  v_lshl_or_b32 v98, v66, 16, v67
  v_lshl_or_b32 v99, v64, 16, v65
  v_lshl_or_b32 v100, v71, 16, v72
  v_lshl_or_b32 v101, v69, 16, v70
  v_lshl_or_b32 v102, v67, 16, v68
  v_lshl_or_b32 v103, v65, 16, v66
  v_lshl_or_b32 v104, v72, 16, v73
  v_lshl_or_b32 v105, v70, 16, v71
  v_lshl_or_b32 v106, v68, 16, v69
  v_lshl_or_b32 v107, v66, 16, v67
  v_lshl_or_b32 v108, v73, 16, v74
  v_lshl_or_b32 v109, v71, 16, v72
  v_lshl_or_b32 v110, v69, 16, v70
  v_lshl_or_b32 v111, v67, 16, v68
  v_lshl_or_b32 v112, v81, 16, v82
  v_lshl_or_b32 v113, v79, 16, v80
  v_lshl_or_b32 v114, v77, 16, v78
  v_lshl_or_b32 v115, v75, 16, v76
  v_lshl_or_b32 v116, v82, 16, v83
  v_lshl_or_b32 v117, v80, 16, v81
  v_lshl_or_b32 v118, v78, 16, v79
  v_lshl_or_b32 v119, v76, 16, v77
  v_lshl_or_b32 v120, v83, 16, v84
  v_lshl_or_b32 v121, v81, 16, v82
  v_lshl_or_b32 v122, v79, 16, v80
  v_lshl_or_b32 v123, v77, 16, v78
  v_lshl_or_b32 v124, v84, 16, v85
  v_lshl_or_b32 v125, v82, 16, v83
  v_lshl_or_b32 v126, v80, 16, v81
  v_lshl_or_b32 v127, v78, 16, v79
  v_mov_b32 v20, 0
  v_mov_b32 v21, 0
  v_mov_b32 v22, 0
  v_mov_b32 v23, 0
  s_branch H_JOIN
K_MAIN:
  s_waitcnt lgkmcnt(0)
  s_mov_b32 s16, s64
  s_mov_b32 s17, s65
  s_mov_b32 s18, 0x1000000
  s_mov_b32 s19, 0x20000
  s_cmp_ge_u32 s25, 28
  s_cbranch_scc1 K_PREP
  s_cmp_eq_u32 s69, 0
  s_mov_b32 s75, 98304
  s_cselect_b32 s75, 131072, s75
  v_lshl_add_u32 v6, s71, 6, v1
  v_mul_u32_u24 v211, 112, v6
  v_add_u32 v211, s75, v211
  v_and_b32 v2, 15, v1
  v_lshrrev_b32 v3, 4, v1
  v_bfe_u32 v4, v1, 1, 3
  v_xor_b32 v4, v4, v3
  v_lshlrev_b32 v2, 7, v2
  v_add_u32 v2, 65536, v2
  v_lshl_add_u32 v8, v4, 4, v2
  v_xor_b32 v9, 64, v8
  v_bfe_u32 v4, v1, 2, 2
  v_lshl_add_u32 v5, v3, 3, v4
  v_lshlrev_b32 v5, 8, v5
  v_and_b32 v6, 3, v1
  v_lshl_add_u32 v5, v6, 3, v5
  v_and_b32 v2, 1, v3
  v_lshl_add_u32 v4, v4, 1, v2
  s_lshl_b32 s29, s3, 1
  v_xor_b32 v4, s29, v4
  v_lshl_add_u32 v12, v4, 5, v5
  v_xor_b32 v13, 32, v12
  v_add_u32 v14, 114688, v12
  v_add_u32 v15, 114688, v13
  s_mov_b32 s20, s56
  s_mov_b32 s21, s57
  s_mov_b32 s22, 0x1c0000
  s_mov_b32 s23, 0x20000
  s_setprio 1
  s_waitcnt vmcnt(0)
  v_lshlrev_b32 v180, 16, v180
  v_lshlrev_b32 v181, 16, v181
  v_lshlrev_b32 v182, 16, v182
  v_lshlrev_b32 v183, 16, v183
  v_lshlrev_b32 v184, 16, v184
  v_lshlrev_b32 v185, 16, v185
  v_lshlrev_b32 v186, 16, v186
  v_mul_f32 v186, 0x3fb8aa3b, v186
  v_exp_f32 v186, v186
  s_nop 0
  v_cvt_pk_bf16_f32 v186, v186, v186
  v_lshlrev_b32 v186, 16, v186
  v_mul_f32 v180, v186, v180
  v_mul_f32 v181, v186, v181
  v_mul_f32 v180, 0x3fb8aa3b, v180
  v_mul_f32 v181, 0x3e22f983, v181
  v_mul_f32 v28, 0x41000000, v180
  v_mul_f32 v182, v186, v182
  v_mul_f32 v183, v186, v183
  v_mul_f32 v46, 0x41800000, v180
  v_pk_mul_f32 v[188:189], v[184:185], v[182:183] op_sel:[1,1] op_sel_hi:[1,0]
  v_mul_f32 v29, 0x41000000, v181
  v_pk_fma_f32 v[128:129], v[184:185], v[182:183], v[188:189] op_sel:[0,0,0] op_sel_hi:[0,1,1] neg_lo:[0,0,1]
  v_mul_f32 v47, 0x41800000, v181
  v_mul_f32 v190, 0x3f800000, v180
  v_mul_f32 v44, 0x43800000, v180
  v_exp_f32 v28, v28
  v_mul_f32 v191, 0x3f800000, v181
  v_exp_f32 v46, v46
  v_mul_f32 v45, 0x43800000, v181
  v_fract_f32 v29, v29
  v_exp_f32 v190, v190
  v_fract_f32 v47, v47
  v_exp_f32 v44, v44
  v_fract_f32 v191, v191
  v_cos_f32 v42, v29
  v_fract_f32 v45, v45
  v_cos_f32 v194, v47
  v_cos_f32 v192, v191
  v_sin_f32 v43, v29
  v_cos_f32 v196, v45
  v_sin_f32 v195, v47
  v_sin_f32 v193, v191
  v_sin_f32 v197, v45
  v_mul_f32 v42, v28, v42
  v_mul_f32 v192, v190, v192
  v_mul_f32 v194, v46, v194
  v_mul_f32 v196, v44, v196
  v_mul_f32 v43, v28, v43
  v_mul_f32 v193, v190, v193
  v_mul_f32 v195, v46, v195
  v_mul_f32 v197, v44, v197
  v_pk_mul_f32 v[190:191], v[128:129], v[192:193] op_sel:[1,1] op_sel_hi:[1,0]
  v_cvt_pk_bf16_f32 v76, 1.0, v42
  v_pk_mul_f32 v[44:45], v[128:129], v[196:197] op_sel:[1,1] op_sel_hi:[1,0]
  v_cvt_pk_bf16_f32 v108, 0, v43
  v_pk_fma_f32 v[130:131], v[128:129], v[192:193], v[190:191] op_sel:[0,0,0] op_sel_hi:[0,1,1] neg_lo:[0,0,1]
  v_mov_b32 v40, v194
  v_pk_fma_f32 v[144:145], v[128:129], v[196:197], v[44:45] op_sel:[0,0,0] op_sel_hi:[0,1,1] neg_lo:[0,0,1]
  v_cvt_pk_bf16_f32 v64, v128, v130
  v_pk_mul_f32 v[46:47], v[42:43], v[194:195] op_sel:[1,1] op_sel_hi:[1,0]
  v_cvt_pk_bf16_f32 v96, -v129, -v131
  v_mov_b32 v41, v195
  v_pk_mul_f32 v[190:191], v[130:131], v[192:193] op_sel:[1,1] op_sel_hi:[1,0]
  v_pk_fma_f32 v[42:43], v[42:43], v[194:195], v[46:47] op_sel:[0,0,0] op_sel_hi:[0,1,1] neg_lo:[0,0,1]
  v_pk_mul_f32 v[44:45], v[144:145], v[196:197] op_sel:[1,1] op_sel_hi:[1,0]
  v_cvt_pk_bf16_f32 v77, v40, v42
  v_pk_fma_f32 v[132:133], v[130:131], v[192:193], v[190:191] op_sel:[0,0,0] op_sel_hi:[0,1,1] neg_lo:[0,0,1]
  v_pk_fma_f32 v[152:153], v[144:145], v[196:197], v[44:45] op_sel:[0,0,0] op_sel_hi:[0,1,1] neg_lo:[0,0,1]
  v_cvt_pk_bf16_f32 v109, v41, v43
  v_pk_mul_f32 v[190:191], v[132:133], v[192:193] op_sel:[1,1] op_sel_hi:[1,0]
  v_pk_mul_f32 v[28:29], v[40:41], v[194:195] op_sel:[1,1] op_sel_hi:[1,0]
  v_pk_mul_f32 v[44:45], v[152:153], v[196:197] op_sel:[1,1] op_sel_hi:[1,0]
  v_pk_mul_f32 v[46:47], v[42:43], v[194:195] op_sel:[1,1] op_sel_hi:[1,0]
  v_pk_fma_f32 v[134:135], v[132:133], v[192:193], v[190:191] op_sel:[0,0,0] op_sel_hi:[0,1,1] neg_lo:[0,0,1]
  v_pk_fma_f32 v[40:41], v[40:41], v[194:195], v[28:29] op_sel:[0,0,0] op_sel_hi:[0,1,1] neg_lo:[0,0,1]
  v_pk_fma_f32 v[156:157], v[152:153], v[196:197], v[44:45] op_sel:[0,0,0] op_sel_hi:[0,1,1] neg_lo:[0,0,1]
  v_cvt_pk_bf16_f32 v65, v132, v134
  v_pk_fma_f32 v[42:43], v[42:43], v[194:195], v[46:47] op_sel:[0,0,0] op_sel_hi:[0,1,1] neg_lo:[0,0,1]
  v_cvt_pk_bf16_f32 v97, -v133, -v135
  v_cvt_pk_bf16_f32 v78, v40, v42
  v_pk_mul_f32 v[190:191], v[134:135], v[192:193] op_sel:[1,1] op_sel_hi:[1,0]
  v_cvt_pk_bf16_f32 v110, v41, v43
  v_pk_mul_f32 v[44:45], v[156:157], v[196:197] op_sel:[1,1] op_sel_hi:[1,0]
  v_pk_mul_f32 v[28:29], v[40:41], v[194:195] op_sel:[1,1] op_sel_hi:[1,0]
  v_pk_fma_f32 v[136:137], v[134:135], v[192:193], v[190:191] op_sel:[0,0,0] op_sel_hi:[0,1,1] neg_lo:[0,0,1]
  v_pk_fma_f32 v[160:161], v[156:157], v[196:197], v[44:45] op_sel:[0,0,0] op_sel_hi:[0,1,1] neg_lo:[0,0,1]
  v_pk_mul_f32 v[46:47], v[42:43], v[194:195] op_sel:[1,1] op_sel_hi:[1,0]
  v_pk_mul_f32 v[190:191], v[136:137], v[192:193] op_sel:[1,1] op_sel_hi:[1,0]
  v_pk_fma_f32 v[40:41], v[40:41], v[194:195], v[28:29] op_sel:[0,0,0] op_sel_hi:[0,1,1] neg_lo:[0,0,1]
  v_pk_mul_f32 v[44:45], v[160:161], v[196:197] op_sel:[1,1] op_sel_hi:[1,0]
  v_pk_fma_f32 v[42:43], v[42:43], v[194:195], v[46:47] op_sel:[0,0,0] op_sel_hi:[0,1,1] neg_lo:[0,0,1]
  v_pk_fma_f32 v[138:139], v[136:137], v[192:193], v[190:191] op_sel:[0,0,0] op_sel_hi:[0,1,1] neg_lo:[0,0,1]
  v_cvt_pk_bf16_f32 v79, v40, v42
  v_pk_fma_f32 v[162:163], v[160:161], v[196:197], v[44:45] op_sel:[0,0,0] op_sel_hi:[0,1,1] neg_lo:[0,0,1]
  v_cvt_pk_bf16_f32 v66, v136, v138
  ds_write_b128 v211, v[76:79] offset:48
  v_cvt_pk_bf16_f32 v98, -v137, -v139
  v_cvt_pk_bf16_f32 v111, v41, v43
  v_cvt_pk_bf16_f32 v72, v160, v162
  v_cvt_pk_bf16_f32 v104, -v161, -v163
  v_pk_mul_f32 v[190:191], v[138:139], v[192:193] op_sel:[1,1] op_sel_hi:[1,0]
  v_pk_mul_f32 v[28:29], v[40:41], v[194:195] op_sel:[1,1] op_sel_hi:[1,0]
  v_pk_mul_f32 v[44:45], v[162:163], v[196:197] op_sel:[1,1] op_sel_hi:[1,0]
  v_pk_mul_f32 v[46:47], v[42:43], v[194:195] op_sel:[1,1] op_sel_hi:[1,0]
  ds_write_b128 v211, v[108:111] offset:14384
  v_pk_fma_f32 v[140:141], v[138:139], v[192:193], v[190:191] op_sel:[0,0,0] op_sel_hi:[0,1,1] neg_lo:[0,0,1]
  v_pk_fma_f32 v[40:41], v[40:41], v[194:195], v[28:29] op_sel:[0,0,0] op_sel_hi:[0,1,1] neg_lo:[0,0,1]
  v_pk_fma_f32 v[164:165], v[162:163], v[196:197], v[44:45] op_sel:[0,0,0] op_sel_hi:[0,1,1] neg_lo:[0,0,1]
  v_pk_fma_f32 v[42:43], v[42:43], v[194:195], v[46:47] op_sel:[0,0,0] op_sel_hi:[0,1,1] neg_lo:[0,0,1]
  v_pk_mul_f32 v[190:191], v[140:141], v[192:193] op_sel:[1,1] op_sel_hi:[1,0]
  v_pk_mul_f32 v[44:45], v[164:165], v[196:197] op_sel:[1,1] op_sel_hi:[1,0]
  v_cvt_pk_bf16_f32 v80, v40, v42
  v_pk_fma_f32 v[142:143], v[140:141], v[192:193], v[190:191] op_sel:[0,0,0] op_sel_hi:[0,1,1] neg_lo:[0,0,1]
  v_cvt_pk_bf16_f32 v112, v41, v43
  v_pk_fma_f32 v[166:167], v[164:165], v[196:197], v[44:45] op_sel:[0,0,0] op_sel_hi:[0,1,1] neg_lo:[0,0,1]
  v_pk_mul_f32 v[28:29], v[40:41], v[194:195] op_sel:[1,1] op_sel_hi:[1,0]
  v_cvt_pk_bf16_f32 v67, v140, v142
  v_pk_mul_f32 v[46:47], v[42:43], v[194:195] op_sel:[1,1] op_sel_hi:[1,0]
  ds_write_b128 v211, v[64:67] offset:0
  v_cvt_pk_bf16_f32 v99, -v141, -v143
  v_pk_fma_f32 v[40:41], v[40:41], v[194:195], v[28:29] op_sel:[0,0,0] op_sel_hi:[0,1,1] neg_lo:[0,0,1]
  v_pk_fma_f32 v[42:43], v[42:43], v[194:195], v[46:47] op_sel:[0,0,0] op_sel_hi:[0,1,1] neg_lo:[0,0,1]
  v_cvt_pk_bf16_f32 v73, v164, v166
  v_cvt_pk_bf16_f32 v81, v40, v42
  v_cvt_pk_bf16_f32 v105, -v165, -v167
  v_cvt_pk_bf16_f32 v113, v41, v43
  v_pk_mul_f32 v[190:191], v[136:137], v[196:197] op_sel:[1,1] op_sel_hi:[1,0]
  ds_write_b128 v211, v[96:99] offset:14336
  v_pk_mul_f32 v[44:45], v[166:167], v[196:197] op_sel:[1,1] op_sel_hi:[1,0]
  v_pk_mul_f32 v[28:29], v[40:41], v[194:195] op_sel:[1,1] op_sel_hi:[1,0]
  v_pk_fma_f32 v[148:149], v[136:137], v[196:197], v[190:191] op_sel:[0,0,0] op_sel_hi:[0,1,1] neg_lo:[0,0,1]
  v_pk_mul_f32 v[46:47], v[42:43], v[194:195] op_sel:[1,1] op_sel_hi:[1,0]
  v_pk_fma_f32 v[168:169], v[166:167], v[196:197], v[44:45] op_sel:[0,0,0] op_sel_hi:[0,1,1] neg_lo:[0,0,1]
  v_pk_fma_f32 v[40:41], v[40:41], v[194:195], v[28:29] op_sel:[0,0,0] op_sel_hi:[0,1,1] neg_lo:[0,0,1]
  v_cvt_pk_bf16_f32 v74, v168, v168
  v_pk_fma_f32 v[42:43], v[42:43], v[194:195], v[46:47] op_sel:[0,0,0] op_sel_hi:[0,1,1] neg_lo:[0,0,1]
  ds_write_b128 v211, v[72:75] offset:32
  v_cvt_pk_bf16_f32 v106, -v169, -v169
  v_cvt_pk_bf16_f32 v82, v40, v42
  v_cvt_pk_bf16_f32 v114, v41, v43
  v_pk_mul_f32 v[190:191], v[148:149], v[196:197] op_sel:[1,1] op_sel_hi:[1,0]
  v_pk_mul_f32 v[28:29], v[40:41], v[194:195] op_sel:[1,1] op_sel_hi:[1,0]
  v_pk_mul_f32 v[44:45], v[132:133], v[196:197] op_sel:[1,1] op_sel_hi:[1,0]
  v_pk_fma_f32 v[154:155], v[148:149], v[196:197], v[190:191] op_sel:[0,0,0] op_sel_hi:[0,1,1] neg_lo:[0,0,1]
  v_pk_mul_f32 v[46:47], v[42:43], v[194:195] op_sel:[1,1] op_sel_hi:[1,0]
  ds_write_b128 v211, v[104:107] offset:14368
  v_pk_fma_f32 v[146:147], v[132:133], v[196:197], v[44:45] op_sel:[0,0,0] op_sel_hi:[0,1,1] neg_lo:[0,0,1]
  v_pk_fma_f32 v[40:41], v[40:41], v[194:195], v[28:29] op_sel:[0,0,0] op_sel_hi:[0,1,1] neg_lo:[0,0,1]
  v_cvt_pk_bf16_f32 v68, v144, v146
  v_pk_fma_f32 v[42:43], v[42:43], v[194:195], v[46:47] op_sel:[0,0,0] op_sel_hi:[0,1,1] neg_lo:[0,0,1]
  v_cvt_pk_bf16_f32 v100, -v145, -v147
  v_cvt_pk_bf16_f32 v83, v40, v42
  v_cvt_pk_bf16_f32 v70, v152, v154
  v_cvt_pk_bf16_f32 v102, -v153, -v155
  ds_write_b128 v211, v[80:83] offset:64
  v_pk_mul_f32 v[190:191], v[154:155], v[196:197] op_sel:[1,1] op_sel_hi:[1,0]
  v_cvt_pk_bf16_f32 v115, v41, v43
  v_pk_mul_f32 v[44:45], v[140:141], v[196:197] op_sel:[1,1] op_sel_hi:[1,0]
  v_pk_fma_f32 v[158:159], v[154:155], v[196:197], v[190:191] op_sel:[0,0,0] op_sel_hi:[0,1,1] neg_lo:[0,0,1]
  v_pk_mul_f32 v[28:29], v[40:41], v[194:195] op_sel:[1,1] op_sel_hi:[1,0]
  v_pk_fma_f32 v[150:151], v[140:141], v[196:197], v[44:45] op_sel:[0,0,0] op_sel_hi:[0,1,1] neg_lo:[0,0,1]
  v_cvt_pk_bf16_f32 v69, v148, v150
  v_pk_mul_f32 v[46:47], v[42:43], v[194:195] op_sel:[1,1] op_sel_hi:[1,0]
  ds_write_b128 v211, v[112:115] offset:14400
  v_cvt_pk_bf16_f32 v101, -v149, -v151
  v_pk_fma_f32 v[40:41], v[40:41], v[194:195], v[28:29] op_sel:[0,0,0] op_sel_hi:[0,1,1] neg_lo:[0,0,1]
  v_cvt_pk_bf16_f32 v71, v156, v158
  v_pk_fma_f32 v[42:43], v[42:43], v[194:195], v[46:47] op_sel:[0,0,0] op_sel_hi:[0,1,1] neg_lo:[0,0,1]
  v_cvt_pk_bf16_f32 v84, v40, v42
  v_cvt_pk_bf16_f32 v103, -v157, -v159
  v_cvt_pk_bf16_f32 v116, v41, v43
  v_pk_mul_f32 v[28:29], v[40:41], v[194:195] op_sel:[1,1] op_sel_hi:[1,0]
  ds_write_b128 v211, v[68:71] offset:16
  v_pk_mul_f32 v[46:47], v[42:43], v[194:195] op_sel:[1,1] op_sel_hi:[1,0]
  v_pk_fma_f32 v[40:41], v[40:41], v[194:195], v[28:29] op_sel:[0,0,0] op_sel_hi:[0,1,1] neg_lo:[0,0,1]
  v_pk_fma_f32 v[42:43], v[42:43], v[194:195], v[46:47] op_sel:[0,0,0] op_sel_hi:[0,1,1] neg_lo:[0,0,1]
  v_cvt_pk_bf16_f32 v85, v40, v42
  v_cvt_pk_bf16_f32 v117, v41, v43
  v_pk_mul_f32 v[28:29], v[40:41], v[194:195] op_sel:[1,1] op_sel_hi:[1,0]
  v_pk_mul_f32 v[46:47], v[42:43], v[194:195] op_sel:[1,1] op_sel_hi:[1,0]
  v_pk_fma_f32 v[40:41], v[40:41], v[194:195], v[28:29] op_sel:[0,0,0] op_sel_hi:[0,1,1] neg_lo:[0,0,1]
  ds_write_b128 v211, v[100:103] offset:14352
  v_pk_fma_f32 v[42:43], v[42:43], v[194:195], v[46:47] op_sel:[0,0,0] op_sel_hi:[0,1,1] neg_lo:[0,0,1]
  v_cvt_pk_bf16_f32 v86, v40, v42
  v_cvt_pk_bf16_f32 v118, v41, v43
  v_pk_mul_f32 v[28:29], v[40:41], v[194:195] op_sel:[1,1] op_sel_hi:[1,0]
  v_pk_mul_f32 v[46:47], v[42:43], v[194:195] op_sel:[1,1] op_sel_hi:[1,0]
  v_pk_fma_f32 v[40:41], v[40:41], v[194:195], v[28:29] op_sel:[0,0,0] op_sel_hi:[0,1,1] neg_lo:[0,0,1]
  v_pk_fma_f32 v[42:43], v[42:43], v[194:195], v[46:47] op_sel:[0,0,0] op_sel_hi:[0,1,1] neg_lo:[0,0,1]
  v_cvt_pk_bf16_f32 v87, v40, v42
  ds_write_b128 v211, v[84:87] offset:80
  v_cvt_pk_bf16_f32 v119, v41, v43
  v_pk_mul_f32 v[28:29], v[40:41], v[194:195] op_sel:[1,1] op_sel_hi:[1,0]
  v_pk_mul_f32 v[46:47], v[42:43], v[194:195] op_sel:[1,1] op_sel_hi:[1,0]
  v_pk_fma_f32 v[40:41], v[40:41], v[194:195], v[28:29] op_sel:[0,0,0] op_sel_hi:[0,1,1] neg_lo:[0,0,1]
  v_pk_fma_f32 v[42:43], v[42:43], v[194:195], v[46:47] op_sel:[0,0,0] op_sel_hi:[0,1,1] neg_lo:[0,0,1]
  v_cvt_pk_bf16_f32 v88, v40, v42
  v_cvt_pk_bf16_f32 v120, v41, v43
  v_pk_mul_f32 v[28:29], v[40:41], v[194:195] op_sel:[1,1] op_sel_hi:[1,0]
  ds_write_b128 v211, v[116:119] offset:14416
  v_pk_mul_f32 v[46:47], v[42:43], v[194:195] op_sel:[1,1] op_sel_hi:[1,0]
  v_pk_fma_f32 v[40:41], v[40:41], v[194:195], v[28:29] op_sel:[0,0,0] op_sel_hi:[0,1,1] neg_lo:[0,0,1]
  v_pk_fma_f32 v[42:43], v[42:43], v[194:195], v[46:47] op_sel:[0,0,0] op_sel_hi:[0,1,1] neg_lo:[0,0,1]
  v_cvt_pk_bf16_f32 v89, v40, v42
  v_cvt_pk_bf16_f32 v121, v41, v43
  v_pk_mul_f32 v[28:29], v[40:41], v[194:195] op_sel:[1,1] op_sel_hi:[1,0]
  v_pk_mul_f32 v[46:47], v[42:43], v[194:195] op_sel:[1,1] op_sel_hi:[1,0]
  v_pk_fma_f32 v[40:41], v[40:41], v[194:195], v[28:29] op_sel:[0,0,0] op_sel_hi:[0,1,1] neg_lo:[0,0,1]
  v_pk_fma_f32 v[42:43], v[42:43], v[194:195], v[46:47] op_sel:[0,0,0] op_sel_hi:[0,1,1] neg_lo:[0,0,1]
  v_cvt_pk_bf16_f32 v90, v40, v42
  v_cvt_pk_bf16_f32 v122, v41, v43
  v_pk_mul_f32 v[28:29], v[40:41], v[194:195] op_sel:[1,1] op_sel_hi:[1,0]
  v_pk_mul_f32 v[46:47], v[42:43], v[194:195] op_sel:[1,1] op_sel_hi:[1,0]
  v_pk_fma_f32 v[40:41], v[40:41], v[194:195], v[28:29] op_sel:[0,0,0] op_sel_hi:[0,1,1] neg_lo:[0,0,1]
  v_pk_fma_f32 v[42:43], v[42:43], v[194:195], v[46:47] op_sel:[0,0,0] op_sel_hi:[0,1,1] neg_lo:[0,0,1]
  v_cvt_pk_bf16_f32 v91, v40, v42
  ds_write_b128 v211, v[88:91] offset:96
  v_cvt_pk_bf16_f32 v123, v41, v43
  ds_write_b128 v211, v[120:123] offset:14432
  s_waitcnt lgkmcnt(0)
  s_barrier
  ds_read_b128 v[48:51], v8 offset:0
  ds_read_b64_tr_b16 v[16:17], v12 offset:0
  ds_read_b64_tr_b16 v[18:19], v12 offset:1024
  ds_read_b64_tr_b16 v[20:21], v12 offset:8192
  ds_read_b64_tr_b16 v[22:23], v12 offset:9216
  ds_read_b64_tr_b16 v[24:25], v13 offset:0
  ds_read_b64_tr_b16 v[26:27], v13 offset:1024
  ds_read_b64_tr_b16 v[28:29], v13 offset:8192
  ds_read_b64_tr_b16 v[30:31], v13 offset:9216
  ds_read_b128 v[52:55], v8 offset:2048
  ds_read_b128 v[56:59], v8 offset:4096
  ds_read_b128 v[60:63], v8 offset:6144
  s_waitcnt lgkmcnt(3)
  v_mfma_f32_16x16x32_bf16 v[128:131], v[16:19], v[48:51], 0
  ds_read_b128 v[64:67], v8 offset:8192
  v_mfma_f32_16x16x32_bf16 v[136:139], v[20:23], v[48:51], 0
  s_sub_u32 s29, s2, 32
  v_mfma_f32_16x16x32_bf16 v[192:195], v[24:27], v[48:51], 0
  s_lshl_b32 s29, s29, 13
  v_mfma_f32_16x16x32_bf16 v[200:203], v[28:31], v[48:51], 0
  s_lshl_b32 s30, s3, 11
  s_waitcnt lgkmcnt(3)
  v_mfma_f32_16x16x32_bf16 v[132:135], v[16:19], v[52:55], 0
  ds_read_b128 v[68:71], v8 offset:10240
  v_mfma_f32_16x16x32_bf16 v[140:143], v[20:23], v[52:55], 0
  s_add_u32 s29, s29, s30
  v_mfma_f32_16x16x32_bf16 v[196:199], v[24:27], v[52:55], 0
  v_lshlrev_b32 v4, 7, v1
  v_mfma_f32_16x16x32_bf16 v[204:207], v[28:31], v[52:55], 0
  s_mov_b64 exec, 0xffff
  buffer_load_dword v126, v4, s[20:23], s29 offen
  s_mov_b64 exec, -1
  s_waitcnt lgkmcnt(3)
  v_mfma_f32_16x16x32_bf16 v[144:147], v[16:19], v[56:59], 0
  ds_read_b128 v[48:51], v8 offset:12288
  v_mfma_f32_16x16x32_bf16 v[152:155], v[20:23], v[56:59], 0
  ds_read_b128 v[52:55], v8 offset:14336
  v_mfma_f32_16x16x32_bf16 v[208:211], v[24:27], v[56:59], 0
  v_mfma_f32_16x16x32_bf16 v[216:219], v[28:31], v[56:59], 0
  s_waitcnt lgkmcnt(4)
  v_mfma_f32_16x16x32_bf16 v[148:151], v[16:19], v[60:63], 0
  v_mfma_f32_16x16x32_bf16 v[156:159], v[20:23], v[60:63], 0
  v_mfma_f32_16x16x32_bf16 v[212:215], v[24:27], v[60:63], 0
  v_mfma_f32_16x16x32_bf16 v[220:223], v[28:31], v[60:63], 0
  s_waitcnt lgkmcnt(0)
  v_mfma_f32_16x16x32_bf16 v[160:163], v[16:19], v[64:67], 0
  s_barrier
  v_mfma_f32_16x16x32_bf16 v[168:171], v[20:23], v[64:67], 0
  ds_read_b128 v[56:59], v9 offset:0
  ds_read_b64_tr_b16 v[32:33], v12 offset:16384
  v_mfma_f32_16x16x32_bf16 v[224:227], v[24:27], v[64:67], 0
  ds_read_b64_tr_b16 v[34:35], v12 offset:17408
  v_mfma_f32_16x16x32_bf16 v[232:235], v[28:31], v[64:67], 0
  ds_read_b64_tr_b16 v[36:37], v12 offset:24576
  v_mfma_f32_16x16x32_bf16 v[164:167], v[16:19], v[68:71], 0
  ds_read_b128 v[60:63], v9 offset:2048
  v_mfma_f32_16x16x32_bf16 v[172:175], v[20:23], v[68:71], 0
  ds_read_b64_tr_b16 v[38:39], v12 offset:25600
  v_mfma_f32_16x16x32_bf16 v[228:231], v[24:27], v[68:71], 0
  ds_read_b64_tr_b16 v[40:41], v13 offset:16384
  v_mfma_f32_16x16x32_bf16 v[236:239], v[28:31], v[68:71], 0
  ds_read_b64_tr_b16 v[42:43], v13 offset:17408
  v_mfma_f32_16x16x32_bf16 v[176:179], v[16:19], v[48:51], 0
  ds_read_b128 v[64:67], v9 offset:4096
  v_mfma_f32_16x16x32_bf16 v[184:187], v[20:23], v[48:51], 0
  ds_read_b64_tr_b16 v[44:45], v13 offset:24576
  v_mfma_f32_16x16x32_bf16 v[240:243], v[24:27], v[48:51], 0
  ds_read_b64_tr_b16 v[46:47], v13 offset:25600
  v_mfma_f32_16x16x32_bf16 v[248:251], v[28:31], v[48:51], 0
  v_mfma_f32_16x16x32_bf16 v[180:183], v[16:19], v[52:55], 0
  ds_read_b128 v[68:71], v9 offset:6144
  v_mfma_f32_16x16x32_bf16 v[188:191], v[20:23], v[52:55], 0
  v_mfma_f32_16x16x32_bf16 v[244:247], v[24:27], v[52:55], 0
  v_mfma_f32_16x16x32_bf16 v[252:255], v[28:31], v[52:55], 0
  s_waitcnt lgkmcnt(1)
  v_mfma_f32_16x16x32_bf16 v[128:131], v[32:35], v[56:59], v[128:131]
  ds_read_b128 v[48:51], v9 offset:8192
  v_lshlrev_b32 v2, 4, v1
  v_mfma_f32_16x16x32_bf16 v[136:139], v[36:39], v[56:59], v[136:139]
  s_mul_i32 s69, s3, 458752
  s_lshl_b32 s12, s68, 7
  v_mfma_f32_16x16x32_bf16 v[192:195], v[40:43], v[56:59], v[192:195]
  s_add_u32 s69, s69, s12
  v_mfma_f32_16x16x32_bf16 v[200:203], v[44:47], v[56:59], v[200:203]
  s_mul_i32 s12, s3, 28672
  v_mfma_f32_16x16x32_bf16 v[132:135], v[32:35], v[60:63], v[132:135]
  ds_read_b128 v[52:55], v9 offset:10240
  s_mul_i32 s10, s67, 229376
  v_mfma_f32_16x16x32_bf16 v[140:143], v[36:39], v[60:63], v[140:143]
  s_add_u32 s10, s10, s12
  s_xor_b32 s11, s3, 3
  v_mfma_f32_16x16x32_bf16 v[196:199], v[40:43], v[60:63], v[196:199]
  s_lshr_b32 s70, s11, 1
  v_mfma_f32_16x16x32_bf16 v[204:207], v[44:47], v[60:63], v[204:207]
  s_mul_i32 s70, s70, 114688
  v_mfma_f32_16x16x32_bf16 v[144:147], v[32:35], v[64:67], v[144:147]
  ds_read_b128 v[56:59], v9 offset:12288
  ds_read_b128 v[60:63], v9 offset:14336
  v_mfma_f32_16x16x32_bf16 v[152:155], v[36:39], v[64:67], v[152:155]
  s_and_b32 s11, s11, 1
  s_lshl_b32 s11, s11, 8
  v_mfma_f32_16x16x32_bf16 v[208:211], v[40:43], v[64:67], v[208:211]
  s_add_u32 s70, s70, s11
  s_add_u32 s70, s70, s10
  v_mfma_f32_16x16x32_bf16 v[216:219], v[44:47], v[64:67], v[216:219]
  s_xor_b32 s11, s3, 2
  s_waitcnt lgkmcnt(4)
  v_mfma_f32_16x16x32_bf16 v[148:151], v[32:35], v[68:71], v[148:151]
  s_lshr_b32 s71, s11, 1
  s_mul_i32 s71, s71, 114688
  v_mfma_f32_16x16x32_bf16 v[156:159], v[36:39], v[68:71], v[156:159]
  s_and_b32 s11, s11, 1
  v_mfma_f32_16x16x32_bf16 v[212:215], v[40:43], v[68:71], v[212:215]
  s_lshl_b32 s11, s11, 8
  v_mfma_f32_16x16x32_bf16 v[220:223], v[44:47], v[68:71], v[220:223]
  s_add_u32 s71, s71, s11
  s_waitcnt lgkmcnt(0)
  v_mfma_f32_16x16x32_bf16 v[160:163], v[32:35], v[48:51], v[160:163]
  s_barrier
  v_mfma_f32_16x16x32_bf16 v[168:171], v[36:39], v[48:51], v[168:171]
  ds_read_b128 v[64:67], v8 offset:16384
  ds_read_b64_tr_b16 v[16:17], v12 offset:32768
  v_mfma_f32_16x16x32_bf16 v[224:227], v[40:43], v[48:51], v[224:227]
  ds_read_b64_tr_b16 v[18:19], v12 offset:33792
  v_mfma_f32_16x16x32_bf16 v[232:235], v[44:47], v[48:51], v[232:235]
  ds_read_b64_tr_b16 v[20:21], v12 offset:40960
  v_mfma_f32_16x16x32_bf16 v[164:167], v[32:35], v[52:55], v[164:167]
  ds_read_b128 v[68:71], v8 offset:18432
  v_mfma_f32_16x16x32_bf16 v[172:175], v[36:39], v[52:55], v[172:175]
  ds_read_b64_tr_b16 v[22:23], v12 offset:41984
  v_mfma_f32_16x16x32_bf16 v[228:231], v[40:43], v[52:55], v[228:231]
  ds_read_b64_tr_b16 v[24:25], v13 offset:32768
  v_mfma_f32_16x16x32_bf16 v[236:239], v[44:47], v[52:55], v[236:239]
  ds_read_b64_tr_b16 v[26:27], v13 offset:33792
  v_mfma_f32_16x16x32_bf16 v[176:179], v[32:35], v[56:59], v[176:179]
  ds_read_b128 v[48:51], v8 offset:20480
  v_mfma_f32_16x16x32_bf16 v[184:187], v[36:39], v[56:59], v[184:187]
  ds_read_b64_tr_b16 v[28:29], v13 offset:40960
  v_mfma_f32_16x16x32_bf16 v[240:243], v[40:43], v[56:59], v[240:243]
  ds_read_b64_tr_b16 v[30:31], v13 offset:41984
  v_mfma_f32_16x16x32_bf16 v[248:251], v[44:47], v[56:59], v[248:251]
  v_mfma_f32_16x16x32_bf16 v[180:183], v[32:35], v[60:63], v[180:183]
  ds_read_b128 v[52:55], v8 offset:22528
  s_add_u32 s71, s71, s10
  v_mfma_f32_16x16x32_bf16 v[188:191], v[36:39], v[60:63], v[188:191]
  s_xor_b32 s11, s3, 1
  s_lshr_b32 s74, s11, 1
  v_mfma_f32_16x16x32_bf16 v[244:247], v[40:43], v[60:63], v[244:247]
  s_mul_i32 s74, s74, 114688
  v_mfma_f32_16x16x32_bf16 v[252:255], v[44:47], v[60:63], v[252:255]
  s_and_b32 s11, s11, 1
  s_waitcnt lgkmcnt(1)
  v_mfma_f32_16x16x32_bf16 v[128:131], v[16:19], v[64:67], v[128:131]
  ds_read_b128 v[56:59], v8 offset:24576
  s_lshl_b32 s11, s11, 8
  v_mfma_f32_16x16x32_bf16 v[136:139], v[20:23], v[64:67], v[136:139]
  s_add_u32 s74, s74, s11
  s_add_u32 s74, s74, s10
  v_mfma_f32_16x16x32_bf16 v[192:195], v[24:27], v[64:67], v[192:195]
  s_xor_b32 s11, s3, 0
  v_mfma_f32_16x16x32_bf16 v[200:203], v[28:31], v[64:67], v[200:203]
  s_lshr_b32 s75, s11, 1
  v_mfma_f32_16x16x32_bf16 v[132:135], v[16:19], v[68:71], v[132:135]
  ds_read_b128 v[60:63], v8 offset:26624
  s_mul_i32 s75, s75, 114688
  v_mfma_f32_16x16x32_bf16 v[140:143], v[20:23], v[68:71], v[140:143]
  s_and_b32 s11, s11, 1
  s_lshl_b32 s11, s11, 8
  v_mfma_f32_16x16x32_bf16 v[196:199], v[24:27], v[68:71], v[196:199]
  s_add_u32 s75, s75, s11
  v_mfma_f32_16x16x32_bf16 v[204:207], v[28:31], v[68:71], v[204:207]
  s_add_u32 s75, s75, s10
  v_mfma_f32_16x16x32_bf16 v[144:147], v[16:19], v[48:51], v[144:147]
  ds_read_b128 v[64:67], v8 offset:28672
  ds_read_b128 v[68:71], v8 offset:30720
  v_mfma_f32_16x16x32_bf16 v[152:155], v[20:23], v[48:51], v[152:155]
  s_and_b32 s12, s3, 1
  s_lshr_b32 s13, s3, 1
  v_mfma_f32_16x16x32_bf16 v[208:211], v[24:27], v[48:51], v[208:211]
  s_mul_i32 s9, s3, 20480
  s_mov_b32 s4, s60
  v_mfma_f32_16x16x32_bf16 v[216:219], v[28:31], v[48:51], v[216:219]
  s_mov_b32 s5, s61
  s_waitcnt lgkmcnt(4)
  v_mfma_f32_16x16x32_bf16 v[148:151], v[16:19], v[52:55], v[148:151]
  s_mov_b32 s6, 0x200000
  s_mov_b32 s7, 0x20000
  v_mfma_f32_16x16x32_bf16 v[156:159], v[20:23], v[52:55], v[156:159]
  s_lshl_b32 s14, s67, 6
  v_mfma_f32_16x16x32_bf16 v[212:215], v[24:27], v[52:55], v[212:215]
  s_lshl_b32 s15, s3, 4
  v_mfma_f32_16x16x32_bf16 v[220:223], v[28:31], v[52:55], v[220:223]
  s_add_u32 s14, s14, s15
  s_waitcnt lgkmcnt(0)
  v_mfma_f32_16x16x32_bf16 v[160:163], v[16:19], v[56:59], v[160:163]
  s_barrier
  v_mfma_f32_16x16x32_bf16 v[168:171], v[20:23], v[56:59], v[168:171]
  ds_read_b128 v[48:51], v9 offset:16384
  ds_read_b64_tr_b16 v[32:33], v12 offset:49152
  v_mfma_f32_16x16x32_bf16 v[224:227], v[24:27], v[56:59], v[224:227]
  ds_read_b64_tr_b16 v[34:35], v12 offset:50176
  v_mfma_f32_16x16x32_bf16 v[232:235], v[28:31], v[56:59], v[232:235]
  ds_read_b64_tr_b16 v[36:37], v12 offset:57344
  v_mfma_f32_16x16x32_bf16 v[164:167], v[16:19], v[60:63], v[164:167]
  ds_read_b128 v[52:55], v9 offset:18432
  v_mfma_f32_16x16x32_bf16 v[172:175], v[20:23], v[60:63], v[172:175]
  ds_read_b64_tr_b16 v[38:39], v12 offset:58368
  v_mfma_f32_16x16x32_bf16 v[228:231], v[24:27], v[60:63], v[228:231]
  ds_read_b64_tr_b16 v[40:41], v13 offset:49152
  v_mfma_f32_16x16x32_bf16 v[236:239], v[28:31], v[60:63], v[236:239]
  ds_read_b64_tr_b16 v[42:43], v13 offset:50176
  v_mfma_f32_16x16x32_bf16 v[176:179], v[16:19], v[64:67], v[176:179]
  ds_read_b128 v[56:59], v9 offset:20480
  v_mfma_f32_16x16x32_bf16 v[184:187], v[20:23], v[64:67], v[184:187]
  ds_read_b64_tr_b16 v[44:45], v13 offset:57344
  v_mfma_f32_16x16x32_bf16 v[240:243], v[24:27], v[64:67], v[240:243]
  ds_read_b64_tr_b16 v[46:47], v13 offset:58368
  v_mfma_f32_16x16x32_bf16 v[248:251], v[28:31], v[64:67], v[248:251]
  v_mfma_f32_16x16x32_bf16 v[180:183], v[16:19], v[68:71], v[180:183]
  ds_read_b128 v[60:63], v9 offset:22528
  s_lshl_b32 s15, s14, 2
  v_mfma_f32_16x16x32_bf16 v[188:191], v[20:23], v[68:71], v[188:191]
  s_add_u32 s15, s15, 0xe00000
  s_lshl_b32 s73, s14, 10
  v_mfma_f32_16x16x32_bf16 v[244:247], v[24:27], v[68:71], v[244:247]
  s_lshl_b32 s10, s68, 7
  v_mfma_f32_16x16x32_bf16 v[252:255], v[28:31], v[68:71], v[252:255]
  s_add_u32 s73, s73, s10
  s_waitcnt lgkmcnt(1)
  v_mfma_f32_16x16x32_bf16 v[128:131], v[32:35], v[48:51], v[128:131]
  ds_read_b128 v[64:67], v9 offset:24576
  v_lshrrev_b32 v4, 5, v1
  v_mfma_f32_16x16x32_bf16 v[136:139], v[36:39], v[48:51], v[136:139]
  v_lshlrev_b32 v6, 11, v4
  v_bfe_u32 v4, v1, 4, 1
  v_mfma_f32_16x16x32_bf16 v[192:195], v[40:43], v[48:51], v[192:195]
  v_bfe_u32 v5, v1, 2, 2
  v_mfma_f32_16x16x32_bf16 v[200:203], v[44:47], v[48:51], v[200:203]
  v_lshl_add_u32 v4, v4, 3, v5
  v_mfma_f32_16x16x32_bf16 v[132:135], v[32:35], v[52:55], v[132:135]
  ds_read_b128 v[68:71], v9 offset:26624
  v_lshl_add_u32 v6, v4, 7, v6
  v_mfma_f32_16x16x32_bf16 v[140:143], v[36:39], v[52:55], v[140:143]
  v_and_b32 v4, 3, v1
  v_lshl_add_u32 v6, v4, 3, v6
  v_mfma_f32_16x16x32_bf16 v[196:199], v[40:43], v[52:55], v[196:199]
  v_lshrrev_b32 v5, 1, v5
  v_mfma_f32_16x16x32_bf16 v[204:207], v[44:47], v[52:55], v[204:207]
  v_lshl_add_u32 v6, v5, 6, v6
  v_mfma_f32_16x16x32_bf16 v[144:147], v[32:35], v[56:59], v[144:147]
  ds_read_b128 v[48:51], v9 offset:28672
  ds_read_b128 v[52:55], v9 offset:30720
  v_mfma_f32_16x16x32_bf16 v[152:155], v[36:39], v[56:59], v[152:155]
  s_mul_i32 s29, s3, 4096
  s_add_u32 s29, s29, 131072
  v_mfma_f32_16x16x32_bf16 v[208:211], v[40:43], v[56:59], v[208:211]
  v_bfe_u32 v4, v1, 4, 1
  v_lshl_add_u32 v6, v4, 5, v6
  v_mfma_f32_16x16x32_bf16 v[216:219], v[44:47], v[56:59], v[216:219]
  v_add_u32 v6, s29, v6
  s_waitcnt lgkmcnt(4)
  v_mfma_f32_16x16x32_bf16 v[148:151], v[32:35], v[60:63], v[148:151]
  v_xor_b32 v7, 64, v6
  v_xor_b32 v10, 32, v6
  v_mfma_f32_16x16x32_bf16 v[156:159], v[36:39], v[60:63], v[156:159]
  v_xor_b32 v11, 32, v7
  v_mfma_f32_16x16x32_bf16 v[212:215], v[40:43], v[60:63], v[212:215]
  s_mul_i32 s29, s26, 458752
  v_mfma_f32_16x16x32_bf16 v[220:223], v[44:47], v[60:63], v[220:223]
  s_lshl_b32 s30, s27, 2
  s_waitcnt lgkmcnt(0)
  v_mfma_f32_16x16x32_bf16 v[160:163], v[32:35], v[64:67], v[160:163]
  s_barrier
  v_mfma_f32_16x16x32_bf16 v[168:171], v[36:39], v[64:67], v[168:171]
  ds_read_b128 v[56:59], v8 offset:32768
  ds_read_b64_tr_b16 v[16:17], v14 offset:0
  v_mfma_f32_16x16x32_bf16 v[224:227], v[40:43], v[64:67], v[224:227]
  ds_read_b64_tr_b16 v[18:19], v14 offset:1024
  v_mfma_f32_16x16x32_bf16 v[232:235], v[44:47], v[64:67], v[232:235]
  ds_read_b64_tr_b16 v[20:21], v14 offset:8192
  v_mfma_f32_16x16x32_bf16 v[164:167], v[32:35], v[68:71], v[164:167]
  ds_read_b128 v[60:63], v8 offset:34816
  v_mfma_f32_16x16x32_bf16 v[172:175], v[36:39], v[68:71], v[172:175]
  ds_read_b64_tr_b16 v[22:23], v14 offset:9216
  v_mfma_f32_16x16x32_bf16 v[228:231], v[40:43], v[68:71], v[228:231]
  ds_read_b64_tr_b16 v[24:25], v15 offset:0
  v_mfma_f32_16x16x32_bf16 v[236:239], v[44:47], v[68:71], v[236:239]
  ds_read_b64_tr_b16 v[26:27], v15 offset:1024
  v_mfma_f32_16x16x32_bf16 v[176:179], v[32:35], v[48:51], v[176:179]
  ds_read_b128 v[64:67], v8 offset:36864
  v_mfma_f32_16x16x32_bf16 v[184:187], v[36:39], v[48:51], v[184:187]
  ds_read_b64_tr_b16 v[28:29], v15 offset:8192
  v_mfma_f32_16x16x32_bf16 v[240:243], v[40:43], v[48:51], v[240:243]
  ds_read_b64_tr_b16 v[30:31], v15 offset:9216
  v_mfma_f32_16x16x32_bf16 v[248:251], v[44:47], v[48:51], v[248:251]
  v_mfma_f32_16x16x32_bf16 v[180:183], v[32:35], v[52:55], v[180:183]
  ds_read_b128 v[68:71], v8 offset:38912
  s_add_u32 s30, s30, s3
  v_mfma_f32_16x16x32_bf16 v[188:191], v[36:39], v[52:55], v[188:191]
  s_mul_i32 s28, s30, 4682
  s_lshr_b32 s28, s28, 16
  v_mfma_f32_16x16x32_bf16 v[244:247], v[40:43], v[52:55], v[244:247]
  s_mul_i32 s28, s28, 14
  v_mfma_f32_16x16x32_bf16 v[252:255], v[44:47], v[52:55], v[252:255]
  s_add_u32 s30, s30, s28
  s_waitcnt lgkmcnt(1)
  v_mfma_f32_16x16x32_bf16 v[128:131], v[16:19], v[56:59], v[128:131]
  ds_read_b128 v[48:51], v8 offset:40960
  s_lshl_b32 s30, s30, 10
  v_mfma_f32_16x16x32_bf16 v[136:139], v[20:23], v[56:59], v[136:139]
  s_add_u32 s28, s29, s30
  s_mov_b32 s66, 0xbfb8aa3b
  v_mfma_f32_16x16x32_bf16 v[192:195], v[24:27], v[56:59], v[192:195]
  s_mov_b32 s82, 0xbfb8aa3b
  v_mfma_f32_16x16x32_bf16 v[200:203], v[28:31], v[56:59], v[200:203]
  s_mov_b32 s83, 0xbfb8aa3b
  v_mfma_f32_16x16x32_bf16 v[132:135], v[16:19], v[60:63], v[132:135]
  ds_read_b128 v[52:55], v8 offset:43008
  v_mfma_f32_16x16x32_bf16 v[140:143], v[20:23], v[60:63], v[140:143]
  s_lshl_b32 s24, s26, 8
  v_mfma_f32_16x16x32_bf16 v[196:199], v[24:27], v[60:63], v[196:199]
  s_add_u32 s24, s24, 0xe10000
  v_mfma_f32_16x16x32_bf16 v[204:207], v[28:31], v[60:63], v[204:207]
  s_mov_b32 s81, 3
  v_mfma_f32_16x16x32_bf16 v[144:147], v[16:19], v[64:67], v[144:147]
  ds_read_b128 v[56:59], v8 offset:45056
  v_mfma_f32_16x16x32_bf16 v[152:155], v[20:23], v[64:67], v[152:155]
  ds_read_b128 v[60:63], v8 offset:47104
  v_mfma_f32_16x16x32_bf16 v[208:211], v[24:27], v[64:67], v[208:211]
  v_mfma_f32_16x16x32_bf16 v[216:219], v[28:31], v[64:67], v[216:219]
  s_waitcnt lgkmcnt(4)
  v_mfma_f32_16x16x32_bf16 v[148:151], v[16:19], v[68:71], v[148:151]
  v_mfma_f32_16x16x32_bf16 v[156:159], v[20:23], v[68:71], v[156:159]
  v_mfma_f32_16x16x32_bf16 v[212:215], v[24:27], v[68:71], v[212:215]
  v_mfma_f32_16x16x32_bf16 v[220:223], v[28:31], v[68:71], v[220:223]
  s_waitcnt lgkmcnt(0)
  v_mfma_f32_16x16x32_bf16 v[160:163], v[16:19], v[48:51], v[160:163]
  s_barrier
  v_mfma_f32_16x16x32_bf16 v[168:171], v[20:23], v[48:51], v[168:171]
  ds_read_b128 v[64:67], v9 offset:32768
  ds_read_b64_tr_b16 v[32:33], v12 offset:0
  v_mfma_f32_16x16x32_bf16 v[224:227], v[24:27], v[48:51], v[224:227]
  ds_read_b64_tr_b16 v[34:35], v12 offset:1024
  v_mfma_f32_16x16x32_bf16 v[232:235], v[28:31], v[48:51], v[232:235]
  ds_read_b64_tr_b16 v[36:37], v12 offset:8192
  v_mfma_f32_16x16x32_bf16 v[164:167], v[16:19], v[52:55], v[164:167]
  ds_read_b128 v[68:71], v9 offset:34816
  v_mfma_f32_16x16x32_bf16 v[172:175], v[20:23], v[52:55], v[172:175]
  ds_read_b64_tr_b16 v[38:39], v12 offset:9216
  v_mfma_f32_16x16x32_bf16 v[228:231], v[24:27], v[52:55], v[228:231]
  ds_read_b64_tr_b16 v[40:41], v13 offset:0
  v_mfma_f32_16x16x32_bf16 v[236:239], v[28:31], v[52:55], v[236:239]
  ds_read_b64_tr_b16 v[42:43], v13 offset:1024
  v_mfma_f32_16x16x32_bf16 v[176:179], v[16:19], v[56:59], v[176:179]
  ds_read_b128 v[48:51], v9 offset:36864
  v_mfma_f32_16x16x32_bf16 v[184:187], v[20:23], v[56:59], v[184:187]
  ds_read_b64_tr_b16 v[44:45], v13 offset:8192
  v_mfma_f32_16x16x32_bf16 v[240:243], v[24:27], v[56:59], v[240:243]
  ds_read_b64_tr_b16 v[46:47], v13 offset:9216
  v_mfma_f32_16x16x32_bf16 v[248:251], v[28:31], v[56:59], v[248:251]
  v_mfma_f32_16x16x32_bf16 v[180:183], v[16:19], v[60:63], v[180:183]
  ds_read_b128 v[52:55], v9 offset:38912
  v_mfma_f32_16x16x32_bf16 v[188:191], v[20:23], v[60:63], v[188:191]
  v_mfma_f32_16x16x32_bf16 v[244:247], v[24:27], v[60:63], v[244:247]
  v_mfma_f32_16x16x32_bf16 v[252:255], v[28:31], v[60:63], v[252:255]
  s_waitcnt lgkmcnt(1)
  v_mfma_f32_16x16x32_bf16 v[128:131], v[32:35], v[64:67], v[128:131]
  ds_read_b128 v[56:59], v9 offset:40960
  v_mfma_f32_16x16x32_bf16 v[136:139], v[36:39], v[64:67], v[136:139]
  v_mfma_f32_16x16x32_bf16 v[192:195], v[40:43], v[64:67], v[192:195]
  v_mfma_f32_16x16x32_bf16 v[200:203], v[44:47], v[64:67], v[200:203]
  v_mfma_f32_16x16x32_bf16 v[132:135], v[32:35], v[68:71], v[132:135]
  ds_read_b128 v[60:63], v9 offset:43008
  v_mfma_f32_16x16x32_bf16 v[140:143], v[36:39], v[68:71], v[140:143]
  v_mfma_f32_16x16x32_bf16 v[196:199], v[40:43], v[68:71], v[196:199]
  v_mfma_f32_16x16x32_bf16 v[204:207], v[44:47], v[68:71], v[204:207]
  v_mfma_f32_16x16x32_bf16 v[144:147], v[32:35], v[48:51], v[144:147]
  ds_read_b128 v[64:67], v9 offset:45056
  v_mfma_f32_16x16x32_bf16 v[152:155], v[36:39], v[48:51], v[152:155]
  ds_read_b128 v[68:71], v9 offset:47104
  v_mfma_f32_16x16x32_bf16 v[208:211], v[40:43], v[48:51], v[208:211]
  v_mfma_f32_16x16x32_bf16 v[216:219], v[44:47], v[48:51], v[216:219]
  s_waitcnt lgkmcnt(4)
  v_mfma_f32_16x16x32_bf16 v[148:151], v[32:35], v[52:55], v[148:151]
  v_mfma_f32_16x16x32_bf16 v[156:159], v[36:39], v[52:55], v[156:159]
  v_mfma_f32_16x16x32_bf16 v[212:215], v[40:43], v[52:55], v[212:215]
  v_mfma_f32_16x16x32_bf16 v[220:223], v[44:47], v[52:55], v[220:223]
  s_waitcnt lgkmcnt(0)
  v_mfma_f32_16x16x32_bf16 v[160:163], v[32:35], v[56:59], v[160:163]
  s_barrier
  v_mfma_f32_16x16x32_bf16 v[168:171], v[36:39], v[56:59], v[168:171]
  ds_read_b128 v[48:51], v8 offset:0
  ds_read_b64_tr_b16 v[16:17], v12 offset:16384
  v_mfma_f32_16x16x32_bf16 v[224:227], v[40:43], v[56:59], v[224:227]
  ds_read_b64_tr_b16 v[18:19], v12 offset:17408
  v_mfma_f32_16x16x32_bf16 v[232:235], v[44:47], v[56:59], v[232:235]
  ds_read_b64_tr_b16 v[20:21], v12 offset:24576
  v_mfma_f32_16x16x32_bf16 v[164:167], v[32:35], v[60:63], v[164:167]
  ds_read_b128 v[52:55], v8 offset:2048
  v_mfma_f32_16x16x32_bf16 v[172:175], v[36:39], v[60:63], v[172:175]
  ds_read_b64_tr_b16 v[22:23], v12 offset:25600
  v_mfma_f32_16x16x32_bf16 v[228:231], v[40:43], v[60:63], v[228:231]
  ds_read_b64_tr_b16 v[24:25], v13 offset:16384
  v_mfma_f32_16x16x32_bf16 v[236:239], v[44:47], v[60:63], v[236:239]
  ds_read_b64_tr_b16 v[26:27], v13 offset:17408
  v_mfma_f32_16x16x32_bf16 v[176:179], v[32:35], v[64:67], v[176:179]
  ds_read_b128 v[56:59], v8 offset:4096
  v_mfma_f32_16x16x32_bf16 v[184:187], v[36:39], v[64:67], v[184:187]
  ds_read_b64_tr_b16 v[28:29], v13 offset:24576
  v_mfma_f32_16x16x32_bf16 v[240:243], v[40:43], v[64:67], v[240:243]
  ds_read_b64_tr_b16 v[30:31], v13 offset:25600
  v_mfma_f32_16x16x32_bf16 v[248:251], v[44:47], v[64:67], v[248:251]
  v_mfma_f32_16x16x32_bf16 v[180:183], v[32:35], v[68:71], v[180:183]
  ds_read_b128 v[60:63], v8 offset:6144
  v_mfma_f32_16x16x32_bf16 v[188:191], v[36:39], v[68:71], v[188:191]
  v_mfma_f32_16x16x32_bf16 v[244:247], v[40:43], v[68:71], v[244:247]
  v_mfma_f32_16x16x32_bf16 v[252:255], v[44:47], v[68:71], v[252:255]
  s_waitcnt lgkmcnt(1)
  v_mfma_f32_16x16x32_bf16 v[128:131], v[16:19], v[48:51], v[128:131]
  ds_read_b128 v[64:67], v8 offset:8192
  v_mfma_f32_16x16x32_bf16 v[136:139], v[20:23], v[48:51], v[136:139]
  ds_read_b64_tr_b16 v[72:73], v6 offset:0
  v_mfma_f32_16x16x32_bf16 v[192:195], v[24:27], v[48:51], v[192:195]
  ds_read_b64_tr_b16 v[74:75], v6 offset:512
  v_mfma_f32_16x16x32_bf16 v[200:203], v[28:31], v[48:51], v[200:203]
  ds_read_b64_tr_b16 v[76:77], v10 offset:0
  v_mfma_f32_16x16x32_bf16 v[132:135], v[16:19], v[52:55], v[132:135]
  ds_read_b128 v[68:71], v8 offset:10240
  v_mfma_f32_16x16x32_bf16 v[140:143], v[20:23], v[52:55], v[140:143]
  ds_read_b64_tr_b16 v[78:79], v10 offset:512
  v_mfma_f32_16x16x32_bf16 v[196:199], v[24:27], v[52:55], v[196:199]
  ds_read_b64_tr_b16 v[80:81], v7 offset:0
  v_mfma_f32_16x16x32_bf16 v[204:207], v[28:31], v[52:55], v[204:207]
  ds_read_b64_tr_b16 v[82:83], v7 offset:512
  v_mfma_f32_16x16x32_bf16 v[144:147], v[16:19], v[56:59], v[144:147]
  ds_read_b128 v[48:51], v8 offset:12288
  v_mfma_f32_16x16x32_bf16 v[152:155], v[20:23], v[56:59], v[152:155]
  ds_read_b128 v[52:55], v8 offset:14336
  v_mfma_f32_16x16x32_bf16 v[208:211], v[24:27], v[56:59], v[208:211]
  ds_read_b64_tr_b16 v[84:85], v11 offset:0
  v_mfma_f32_16x16x32_bf16 v[216:219], v[28:31], v[56:59], v[216:219]
  ds_read_b64_tr_b16 v[86:87], v11 offset:512
  s_waitcnt lgkmcnt(12)
  v_mfma_f32_16x16x32_bf16 v[148:151], v[16:19], v[60:63], v[148:151]
  v_mfma_f32_16x16x32_bf16 v[156:159], v[20:23], v[60:63], v[156:159]
  v_mfma_f32_16x16x32_bf16 v[212:215], v[24:27], v[60:63], v[212:215]
  v_mfma_f32_16x16x32_bf16 v[220:223], v[28:31], v[60:63], v[220:223]
  s_waitcnt lgkmcnt(0)
  v_mfma_f32_16x16x32_bf16 v[160:163], v[16:19], v[64:67], v[160:163]
  s_barrier
  v_mfma_f32_16x16x32_bf16 v[168:171], v[20:23], v[64:67], v[168:171]
  ds_read_b128 v[56:59], v9 offset:0
  ds_read_b64_tr_b16 v[32:33], v12 offset:32768
  v_mfma_f32_16x16x32_bf16 v[224:227], v[24:27], v[64:67], v[224:227]
  ds_read_b64_tr_b16 v[34:35], v12 offset:33792
  v_mfma_f32_16x16x32_bf16 v[232:235], v[28:31], v[64:67], v[232:235]
  ds_read_b64_tr_b16 v[36:37], v12 offset:40960
  v_mfma_f32_16x16x32_bf16 v[164:167], v[16:19], v[68:71], v[164:167]
  ds_read_b128 v[60:63], v9 offset:2048
  v_mfma_f32_16x16x32_bf16 v[172:175], v[20:23], v[68:71], v[172:175]
  ds_read_b64_tr_b16 v[38:39], v12 offset:41984
  v_mfma_f32_16x16x32_bf16 v[228:231], v[24:27], v[68:71], v[228:231]
  ds_read_b64_tr_b16 v[40:41], v13 offset:32768
  v_mfma_f32_16x16x32_bf16 v[236:239], v[28:31], v[68:71], v[236:239]
  ds_read_b64_tr_b16 v[42:43], v13 offset:33792
  v_mfma_f32_16x16x32_bf16 v[176:179], v[16:19], v[48:51], v[176:179]
  ds_read_b128 v[64:67], v9 offset:4096
  v_mfma_f32_16x16x32_bf16 v[184:187], v[20:23], v[48:51], v[184:187]
  ds_read_b64_tr_b16 v[44:45], v13 offset:40960
  v_mfma_f32_16x16x32_bf16 v[240:243], v[24:27], v[48:51], v[240:243]
  ds_read_b64_tr_b16 v[46:47], v13 offset:41984
  v_mfma_f32_16x16x32_bf16 v[248:251], v[28:31], v[48:51], v[248:251]
  v_mfma_f32_16x16x32_bf16 v[180:183], v[16:19], v[52:55], v[180:183]
  ds_read_b128 v[68:71], v9 offset:6144
  v_mfma_f32_16x16x32_bf16 v[188:191], v[20:23], v[52:55], v[188:191]
  v_mfma_f32_16x16x32_bf16 v[244:247], v[24:27], v[52:55], v[244:247]
  v_mfma_f32_16x16x32_bf16 v[252:255], v[28:31], v[52:55], v[252:255]
  s_waitcnt lgkmcnt(1)
  v_mfma_f32_16x16x32_bf16 v[128:131], v[32:35], v[56:59], v[128:131]
  ds_read_b128 v[48:51], v9 offset:8192
  v_mfma_f32_16x16x32_bf16 v[136:139], v[36:39], v[56:59], v[136:139]
  v_mfma_f32_16x16x32_bf16 v[192:195], v[40:43], v[56:59], v[192:195]
  v_mfma_f32_16x16x32_bf16 v[200:203], v[44:47], v[56:59], v[200:203]
  v_mfma_f32_16x16x32_bf16 v[132:135], v[32:35], v[60:63], v[132:135]
  ds_read_b128 v[52:55], v9 offset:10240
  v_mfma_f32_16x16x32_bf16 v[140:143], v[36:39], v[60:63], v[140:143]
  v_mfma_f32_16x16x32_bf16 v[196:199], v[40:43], v[60:63], v[196:199]
  v_mfma_f32_16x16x32_bf16 v[204:207], v[44:47], v[60:63], v[204:207]
  v_mfma_f32_16x16x32_bf16 v[144:147], v[32:35], v[64:67], v[144:147]
  ds_read_b128 v[56:59], v9 offset:12288
  v_mfma_f32_16x16x32_bf16 v[152:155], v[36:39], v[64:67], v[152:155]
  ds_read_b128 v[60:63], v9 offset:14336
  v_mfma_f32_16x16x32_bf16 v[208:211], v[40:43], v[64:67], v[208:211]
  v_mfma_f32_16x16x32_bf16 v[216:219], v[44:47], v[64:67], v[216:219]
  s_waitcnt lgkmcnt(4)
  v_mfma_f32_16x16x32_bf16 v[148:151], v[32:35], v[68:71], v[148:151]
  v_mfma_f32_16x16x32_bf16 v[156:159], v[36:39], v[68:71], v[156:159]
  v_mfma_f32_16x16x32_bf16 v[212:215], v[40:43], v[68:71], v[212:215]
  v_mfma_f32_16x16x32_bf16 v[220:223], v[44:47], v[68:71], v[220:223]
  s_waitcnt lgkmcnt(0)
  v_mfma_f32_16x16x32_bf16 v[160:163], v[32:35], v[48:51], v[160:163]
  s_barrier
  v_mfma_f32_16x16x32_bf16 v[168:171], v[36:39], v[48:51], v[168:171]
  ds_read_b128 v[64:67], v8 offset:16384
  ds_read_b64_tr_b16 v[16:17], v12 offset:49152
  v_mfma_f32_16x16x32_bf16 v[224:227], v[40:43], v[48:51], v[224:227]
  ds_read_b64_tr_b16 v[18:19], v12 offset:50176
  v_mfma_f32_16x16x32_bf16 v[232:235], v[44:47], v[48:51], v[232:235]
  ds_read_b64_tr_b16 v[20:21], v12 offset:57344
  v_mfma_f32_16x16x32_bf16 v[164:167], v[32:35], v[52:55], v[164:167]
  ds_read_b128 v[68:71], v8 offset:18432
  v_mfma_f32_16x16x32_bf16 v[172:175], v[36:39], v[52:55], v[172:175]
  ds_read_b64_tr_b16 v[22:23], v12 offset:58368
  v_mfma_f32_16x16x32_bf16 v[228:231], v[40:43], v[52:55], v[228:231]
  ds_read_b64_tr_b16 v[24:25], v13 offset:49152
  v_mfma_f32_16x16x32_bf16 v[236:239], v[44:47], v[52:55], v[236:239]
  ds_read_b64_tr_b16 v[26:27], v13 offset:50176
  v_mfma_f32_16x16x32_bf16 v[176:179], v[32:35], v[56:59], v[176:179]
  ds_read_b128 v[48:51], v8 offset:20480
  v_mfma_f32_16x16x32_bf16 v[184:187], v[36:39], v[56:59], v[184:187]
  ds_read_b64_tr_b16 v[28:29], v13 offset:57344
  v_mfma_f32_16x16x32_bf16 v[240:243], v[40:43], v[56:59], v[240:243]
  ds_read_b64_tr_b16 v[30:31], v13 offset:58368
  v_mfma_f32_16x16x32_bf16 v[248:251], v[44:47], v[56:59], v[248:251]
  v_mfma_f32_16x16x32_bf16 v[180:183], v[32:35], v[60:63], v[180:183]
  ds_read_b128 v[52:55], v8 offset:22528
  v_mfma_f32_16x16x32_bf16 v[188:191], v[36:39], v[60:63], v[188:191]
  v_mfma_f32_16x16x32_bf16 v[244:247], v[40:43], v[60:63], v[244:247]
  v_mfma_f32_16x16x32_bf16 v[252:255], v[44:47], v[60:63], v[252:255]
  s_waitcnt lgkmcnt(1)
  v_mfma_f32_16x16x32_bf16 v[128:131], v[16:19], v[64:67], v[128:131]
  ds_read_b128 v[56:59], v8 offset:24576
  v_mfma_f32_16x16x32_bf16 v[136:139], v[20:23], v[64:67], v[136:139]
  v_mfma_f32_16x16x32_bf16 v[192:195], v[24:27], v[64:67], v[192:195]
  v_mfma_f32_16x16x32_bf16 v[200:203], v[28:31], v[64:67], v[200:203]
  v_mfma_f32_16x16x32_bf16 v[132:135], v[16:19], v[68:71], v[132:135]
  ds_read_b128 v[60:63], v8 offset:26624
  v_mfma_f32_16x16x32_bf16 v[140:143], v[20:23], v[68:71], v[140:143]
  v_mfma_f32_16x16x32_bf16 v[196:199], v[24:27], v[68:71], v[196:199]
  v_mfma_f32_16x16x32_bf16 v[204:207], v[28:31], v[68:71], v[204:207]
  v_mfma_f32_16x16x32_bf16 v[144:147], v[16:19], v[48:51], v[144:147]
  ds_read_b128 v[64:67], v8 offset:28672
  v_mfma_f32_16x16x32_bf16 v[152:155], v[20:23], v[48:51], v[152:155]
  ds_read_b128 v[68:71], v8 offset:30720
  v_mfma_f32_16x16x32_bf16 v[208:211], v[24:27], v[48:51], v[208:211]
  v_mfma_f32_16x16x32_bf16 v[216:219], v[28:31], v[48:51], v[216:219]
  s_waitcnt lgkmcnt(4)
  v_mfma_f32_16x16x32_bf16 v[148:151], v[16:19], v[52:55], v[148:151]
  v_mfma_f32_16x16x32_bf16 v[156:159], v[20:23], v[52:55], v[156:159]
  v_mfma_f32_16x16x32_bf16 v[212:215], v[24:27], v[52:55], v[212:215]
  v_mfma_f32_16x16x32_bf16 v[220:223], v[28:31], v[52:55], v[220:223]
  s_waitcnt lgkmcnt(0)
  v_mfma_f32_16x16x32_bf16 v[160:163], v[16:19], v[56:59], v[160:163]
  s_barrier
  v_mfma_f32_16x16x32_bf16 v[168:171], v[20:23], v[56:59], v[168:171]
  ds_read_b128 v[48:51], v9 offset:16384
  ds_read_b64_tr_b16 v[32:33], v14 offset:0
  v_mfma_f32_16x16x32_bf16 v[224:227], v[24:27], v[56:59], v[224:227]
  ds_read_b64_tr_b16 v[34:35], v14 offset:1024
  v_mfma_f32_16x16x32_bf16 v[232:235], v[28:31], v[56:59], v[232:235]
  ds_read_b64_tr_b16 v[36:37], v14 offset:8192
  v_mfma_f32_16x16x32_bf16 v[164:167], v[16:19], v[60:63], v[164:167]
  ds_read_b128 v[52:55], v9 offset:18432
  v_mfma_f32_16x16x32_bf16 v[172:175], v[20:23], v[60:63], v[172:175]
  ds_read_b64_tr_b16 v[38:39], v14 offset:9216
  v_mfma_f32_16x16x32_bf16 v[228:231], v[24:27], v[60:63], v[228:231]
  ds_read_b64_tr_b16 v[40:41], v15 offset:0
  v_mfma_f32_16x16x32_bf16 v[236:239], v[28:31], v[60:63], v[236:239]
  ds_read_b64_tr_b16 v[42:43], v15 offset:1024
  v_mfma_f32_16x16x32_bf16 v[176:179], v[16:19], v[64:67], v[176:179]
  ds_read_b128 v[56:59], v9 offset:20480
  v_mfma_f32_16x16x32_bf16 v[184:187], v[20:23], v[64:67], v[184:187]
  ds_read_b64_tr_b16 v[44:45], v15 offset:8192
  v_mfma_f32_16x16x32_bf16 v[240:243], v[24:27], v[64:67], v[240:243]
  ds_read_b64_tr_b16 v[46:47], v15 offset:9216
  v_mfma_f32_16x16x32_bf16 v[248:251], v[28:31], v[64:67], v[248:251]
  v_mfma_f32_16x16x32_bf16 v[180:183], v[16:19], v[68:71], v[180:183]
  ds_read_b128 v[60:63], v9 offset:22528
  v_mfma_f32_16x16x32_bf16 v[188:191], v[20:23], v[68:71], v[188:191]
  v_mfma_f32_16x16x32_bf16 v[244:247], v[24:27], v[68:71], v[244:247]
  v_mfma_f32_16x16x32_bf16 v[252:255], v[28:31], v[68:71], v[252:255]
  s_waitcnt lgkmcnt(1)
  v_mfma_f32_16x16x32_bf16 v[128:131], v[32:35], v[48:51], v[128:131]
  ds_read_b128 v[64:67], v9 offset:24576
  v_mfma_f32_16x16x32_bf16 v[136:139], v[36:39], v[48:51], v[136:139]
  ds_read_b64_tr_b16 v[88:89], v6 offset:0
  v_mfma_f32_16x16x32_bf16 v[192:195], v[40:43], v[48:51], v[192:195]
  ds_read_b64_tr_b16 v[90:91], v6 offset:512
  v_mfma_f32_16x16x32_bf16 v[200:203], v[44:47], v[48:51], v[200:203]
  ds_read_b64_tr_b16 v[92:93], v10 offset:0
  v_mfma_f32_16x16x32_bf16 v[132:135], v[32:35], v[52:55], v[132:135]
  ds_read_b128 v[68:71], v9 offset:26624
  v_mfma_f32_16x16x32_bf16 v[140:143], v[36:39], v[52:55], v[140:143]
  ds_read_b64_tr_b16 v[94:95], v10 offset:512
  v_mfma_f32_16x16x32_bf16 v[196:199], v[40:43], v[52:55], v[196:199]
  ds_read_b64_tr_b16 v[96:97], v7 offset:0
  v_mfma_f32_16x16x32_bf16 v[204:207], v[44:47], v[52:55], v[204:207]
  ds_read_b64_tr_b16 v[98:99], v7 offset:512
  v_mfma_f32_16x16x32_bf16 v[144:147], v[32:35], v[56:59], v[144:147]
  ds_read_b128 v[48:51], v9 offset:28672
  v_mfma_f32_16x16x32_bf16 v[152:155], v[36:39], v[56:59], v[152:155]
  ds_read_b128 v[52:55], v9 offset:30720
  v_mfma_f32_16x16x32_bf16 v[208:211], v[40:43], v[56:59], v[208:211]
  ds_read_b64_tr_b16 v[100:101], v11 offset:0
  v_mfma_f32_16x16x32_bf16 v[216:219], v[44:47], v[56:59], v[216:219]
  ds_read_b64_tr_b16 v[102:103], v11 offset:512
  s_waitcnt lgkmcnt(12)
  v_mfma_f32_16x16x32_bf16 v[148:151], v[32:35], v[60:63], v[148:151]
  v_mfma_f32_16x16x32_bf16 v[156:159], v[36:39], v[60:63], v[156:159]
  v_mfma_f32_16x16x32_bf16 v[212:215], v[40:43], v[60:63], v[212:215]
  v_mfma_f32_16x16x32_bf16 v[220:223], v[44:47], v[60:63], v[220:223]
  s_waitcnt lgkmcnt(0)
  v_mfma_f32_16x16x32_bf16 v[160:163], v[32:35], v[64:67], v[160:163]
  s_barrier
  v_mfma_f32_16x16x32_bf16 v[168:171], v[36:39], v[64:67], v[168:171]
  ds_read_b128 v[56:59], v8 offset:32768
  ds_read_b64_tr_b16 v[16:17], v12 offset:0
  v_mfma_f32_16x16x32_bf16 v[224:227], v[40:43], v[64:67], v[224:227]
  ds_read_b64_tr_b16 v[18:19], v12 offset:1024
  v_mfma_f32_16x16x32_bf16 v[232:235], v[44:47], v[64:67], v[232:235]
  ds_read_b64_tr_b16 v[20:21], v12 offset:8192
  v_mfma_f32_16x16x32_bf16 v[164:167], v[32:35], v[68:71], v[164:167]
  ds_read_b128 v[60:63], v8 offset:34816
  v_mfma_f32_16x16x32_bf16 v[172:175], v[36:39], v[68:71], v[172:175]
  ds_read_b64_tr_b16 v[22:23], v12 offset:9216
  v_mfma_f32_16x16x32_bf16 v[228:231], v[40:43], v[68:71], v[228:231]
  ds_read_b64_tr_b16 v[24:25], v13 offset:0
  v_mfma_f32_16x16x32_bf16 v[236:239], v[44:47], v[68:71], v[236:239]
  ds_read_b64_tr_b16 v[26:27], v13 offset:1024
  v_mfma_f32_16x16x32_bf16 v[176:179], v[32:35], v[48:51], v[176:179]
  ds_read_b128 v[64:67], v8 offset:36864
  v_mfma_f32_16x16x32_bf16 v[184:187], v[36:39], v[48:51], v[184:187]
  ds_read_b64_tr_b16 v[28:29], v13 offset:8192
  v_mfma_f32_16x16x32_bf16 v[240:243], v[40:43], v[48:51], v[240:243]
  ds_read_b64_tr_b16 v[30:31], v13 offset:9216
  v_mfma_f32_16x16x32_bf16 v[248:251], v[44:47], v[48:51], v[248:251]
  v_mfma_f32_16x16x32_bf16 v[180:183], v[32:35], v[52:55], v[180:183]
  ds_read_b128 v[68:71], v8 offset:38912
  v_mfma_f32_16x16x32_bf16 v[188:191], v[36:39], v[52:55], v[188:191]
  v_mfma_f32_16x16x32_bf16 v[244:247], v[40:43], v[52:55], v[244:247]
  v_mfma_f32_16x16x32_bf16 v[252:255], v[44:47], v[52:55], v[252:255]
  s_waitcnt lgkmcnt(1)
  v_mfma_f32_16x16x32_bf16 v[128:131], v[16:19], v[56:59], v[128:131]
  ds_read_b128 v[48:51], v8 offset:40960
  v_mfma_f32_16x16x32_bf16 v[136:139], v[20:23], v[56:59], v[136:139]
  v_mfma_f32_16x16x32_bf16 v[192:195], v[24:27], v[56:59], v[192:195]
  v_mfma_f32_16x16x32_bf16 v[200:203], v[28:31], v[56:59], v[200:203]
  v_mfma_f32_16x16x32_bf16 v[132:135], v[16:19], v[60:63], v[132:135]
  ds_read_b128 v[52:55], v8 offset:43008
  v_mfma_f32_16x16x32_bf16 v[140:143], v[20:23], v[60:63], v[140:143]
  v_mfma_f32_16x16x32_bf16 v[196:199], v[24:27], v[60:63], v[196:199]
  v_mfma_f32_16x16x32_bf16 v[204:207], v[28:31], v[60:63], v[204:207]
  v_mfma_f32_16x16x32_bf16 v[144:147], v[16:19], v[64:67], v[144:147]
  ds_read_b128 v[56:59], v8 offset:45056
  v_mfma_f32_16x16x32_bf16 v[152:155], v[20:23], v[64:67], v[152:155]
  ds_read_b128 v[60:63], v8 offset:47104
  v_mfma_f32_16x16x32_bf16 v[208:211], v[24:27], v[64:67], v[208:211]
  v_mfma_f32_16x16x32_bf16 v[216:219], v[28:31], v[64:67], v[216:219]
  s_waitcnt lgkmcnt(4)
  v_mfma_f32_16x16x32_bf16 v[148:151], v[16:19], v[68:71], v[148:151]
  v_mfma_f32_16x16x32_bf16 v[156:159], v[20:23], v[68:71], v[156:159]
  v_mfma_f32_16x16x32_bf16 v[212:215], v[24:27], v[68:71], v[212:215]
  v_mfma_f32_16x16x32_bf16 v[220:223], v[28:31], v[68:71], v[220:223]
  s_waitcnt lgkmcnt(0)
  v_mfma_f32_16x16x32_bf16 v[160:163], v[16:19], v[48:51], v[160:163]
  s_barrier
  v_mfma_f32_16x16x32_bf16 v[168:171], v[20:23], v[48:51], v[168:171]
  ds_read_b128 v[64:67], v9 offset:32768
  ds_read_b64_tr_b16 v[32:33], v12 offset:16384
  v_mfma_f32_16x16x32_bf16 v[224:227], v[24:27], v[48:51], v[224:227]
  ds_read_b64_tr_b16 v[34:35], v12 offset:17408
  v_mfma_f32_16x16x32_bf16 v[232:235], v[28:31], v[48:51], v[232:235]
  ds_read_b64_tr_b16 v[36:37], v12 offset:24576
  v_mfma_f32_16x16x32_bf16 v[164:167], v[16:19], v[52:55], v[164:167]
  ds_read_b128 v[68:71], v9 offset:34816
  v_mfma_f32_16x16x32_bf16 v[172:175], v[20:23], v[52:55], v[172:175]
  ds_read_b64_tr_b16 v[38:39], v12 offset:25600
  v_mfma_f32_16x16x32_bf16 v[228:231], v[24:27], v[52:55], v[228:231]
  ds_read_b64_tr_b16 v[40:41], v13 offset:16384
  v_mfma_f32_16x16x32_bf16 v[236:239], v[28:31], v[52:55], v[236:239]
  ds_read_b64_tr_b16 v[42:43], v13 offset:17408
  v_mfma_f32_16x16x32_bf16 v[176:179], v[16:19], v[56:59], v[176:179]
  ds_read_b128 v[48:51], v9 offset:36864
  v_mfma_f32_16x16x32_bf16 v[184:187], v[20:23], v[56:59], v[184:187]
  ds_read_b64_tr_b16 v[44:45], v13 offset:24576
  v_mfma_f32_16x16x32_bf16 v[240:243], v[24:27], v[56:59], v[240:243]
  ds_read_b64_tr_b16 v[46:47], v13 offset:25600
  v_mfma_f32_16x16x32_bf16 v[248:251], v[28:31], v[56:59], v[248:251]
  v_mfma_f32_16x16x32_bf16 v[180:183], v[16:19], v[60:63], v[180:183]
  ds_read_b128 v[52:55], v9 offset:38912
  v_mfma_f32_16x16x32_bf16 v[188:191], v[20:23], v[60:63], v[188:191]
  v_mfma_f32_16x16x32_bf16 v[244:247], v[24:27], v[60:63], v[244:247]
  v_mfma_f32_16x16x32_bf16 v[252:255], v[28:31], v[60:63], v[252:255]
  s_waitcnt lgkmcnt(1)
  v_mfma_f32_16x16x32_bf16 v[128:131], v[32:35], v[64:67], v[128:131]
  ds_read_b128 v[56:59], v9 offset:40960
  v_mfma_f32_16x16x32_bf16 v[136:139], v[36:39], v[64:67], v[136:139]
  v_mfma_f32_16x16x32_bf16 v[192:195], v[40:43], v[64:67], v[192:195]
  v_mfma_f32_16x16x32_bf16 v[200:203], v[44:47], v[64:67], v[200:203]
  v_mfma_f32_16x16x32_bf16 v[132:135], v[32:35], v[68:71], v[132:135]
  ds_read_b128 v[60:63], v9 offset:43008
  v_mfma_f32_16x16x32_bf16 v[140:143], v[36:39], v[68:71], v[140:143]
  v_mfma_f32_16x16x32_bf16 v[196:199], v[40:43], v[68:71], v[196:199]
  v_mfma_f32_16x16x32_bf16 v[204:207], v[44:47], v[68:71], v[204:207]
  v_mfma_f32_16x16x32_bf16 v[144:147], v[32:35], v[48:51], v[144:147]
  ds_read_b128 v[64:67], v9 offset:45056
  v_mfma_f32_16x16x32_bf16 v[152:155], v[36:39], v[48:51], v[152:155]
  ds_read_b128 v[68:71], v9 offset:47104
  v_mfma_f32_16x16x32_bf16 v[208:211], v[40:43], v[48:51], v[208:211]
  v_mfma_f32_16x16x32_bf16 v[216:219], v[44:47], v[48:51], v[216:219]
  s_waitcnt lgkmcnt(4)
  v_mfma_f32_16x16x32_bf16 v[148:151], v[32:35], v[52:55], v[148:151]
  v_mfma_f32_16x16x32_bf16 v[156:159], v[36:39], v[52:55], v[156:159]
  v_mfma_f32_16x16x32_bf16 v[212:215], v[40:43], v[52:55], v[212:215]
  v_mfma_f32_16x16x32_bf16 v[220:223], v[44:47], v[52:55], v[220:223]
  s_waitcnt lgkmcnt(0)
  v_mfma_f32_16x16x32_bf16 v[160:163], v[32:35], v[56:59], v[160:163]
  s_barrier
  v_mfma_f32_16x16x32_bf16 v[168:171], v[36:39], v[56:59], v[168:171]
  ds_read_b128 v[48:51], v8 offset:0
  ds_read_b64_tr_b16 v[16:17], v12 offset:32768
  v_mfma_f32_16x16x32_bf16 v[224:227], v[40:43], v[56:59], v[224:227]
  ds_read_b64_tr_b16 v[18:19], v12 offset:33792
  v_mfma_f32_16x16x32_bf16 v[232:235], v[44:47], v[56:59], v[232:235]
  ds_read_b64_tr_b16 v[20:21], v12 offset:40960
  v_mfma_f32_16x16x32_bf16 v[164:167], v[32:35], v[60:63], v[164:167]
  ds_read_b128 v[52:55], v8 offset:2048
  v_mfma_f32_16x16x32_bf16 v[172:175], v[36:39], v[60:63], v[172:175]
  ds_read_b64_tr_b16 v[22:23], v12 offset:41984
  v_mfma_f32_16x16x32_bf16 v[228:231], v[40:43], v[60:63], v[228:231]
  ds_read_b64_tr_b16 v[24:25], v13 offset:32768
  v_mfma_f32_16x16x32_bf16 v[236:239], v[44:47], v[60:63], v[236:239]
  ds_read_b64_tr_b16 v[26:27], v13 offset:33792
  v_mfma_f32_16x16x32_bf16 v[176:179], v[32:35], v[64:67], v[176:179]
  ds_read_b128 v[56:59], v8 offset:4096
  v_mfma_f32_16x16x32_bf16 v[184:187], v[36:39], v[64:67], v[184:187]
  ds_read_b64_tr_b16 v[28:29], v13 offset:40960
  v_mfma_f32_16x16x32_bf16 v[240:243], v[40:43], v[64:67], v[240:243]
  ds_read_b64_tr_b16 v[30:31], v13 offset:41984
  v_mfma_f32_16x16x32_bf16 v[248:251], v[44:47], v[64:67], v[248:251]
  v_mfma_f32_16x16x32_bf16 v[180:183], v[32:35], v[68:71], v[180:183]
  ds_read_b128 v[60:63], v8 offset:6144
  v_mfma_f32_16x16x32_bf16 v[188:191], v[36:39], v[68:71], v[188:191]
  v_mfma_f32_16x16x32_bf16 v[244:247], v[40:43], v[68:71], v[244:247]
  v_mfma_f32_16x16x32_bf16 v[252:255], v[44:47], v[68:71], v[252:255]
  s_waitcnt lgkmcnt(1)
  v_mfma_f32_16x16x32_bf16 v[128:131], v[16:19], v[48:51], v[128:131]
  ds_read_b128 v[64:67], v8 offset:8192
  v_mfma_f32_16x16x32_bf16 v[136:139], v[20:23], v[48:51], v[136:139]
  ds_read_b64_tr_b16 v[104:105], v6 offset:0
  v_mfma_f32_16x16x32_bf16 v[192:195], v[24:27], v[48:51], v[192:195]
  ds_read_b64_tr_b16 v[106:107], v6 offset:512
  v_mfma_f32_16x16x32_bf16 v[200:203], v[28:31], v[48:51], v[200:203]
  ds_read_b64_tr_b16 v[108:109], v10 offset:0
  v_mfma_f32_16x16x32_bf16 v[132:135], v[16:19], v[52:55], v[132:135]
  ds_read_b128 v[68:71], v8 offset:10240
  v_mfma_f32_16x16x32_bf16 v[140:143], v[20:23], v[52:55], v[140:143]
  ds_read_b64_tr_b16 v[110:111], v10 offset:512
  v_mfma_f32_16x16x32_bf16 v[196:199], v[24:27], v[52:55], v[196:199]
  ds_read_b64_tr_b16 v[112:113], v7 offset:0
  v_mfma_f32_16x16x32_bf16 v[204:207], v[28:31], v[52:55], v[204:207]
  ds_read_b64_tr_b16 v[114:115], v7 offset:512
  v_mfma_f32_16x16x32_bf16 v[144:147], v[16:19], v[56:59], v[144:147]
  ds_read_b128 v[48:51], v8 offset:12288
  v_mfma_f32_16x16x32_bf16 v[152:155], v[20:23], v[56:59], v[152:155]
  ds_read_b128 v[52:55], v8 offset:14336
  v_mfma_f32_16x16x32_bf16 v[208:211], v[24:27], v[56:59], v[208:211]
  ds_read_b64_tr_b16 v[116:117], v11 offset:0
  v_mfma_f32_16x16x32_bf16 v[216:219], v[28:31], v[56:59], v[216:219]
  ds_read_b64_tr_b16 v[118:119], v11 offset:512
  s_waitcnt lgkmcnt(12)
  v_mfma_f32_16x16x32_bf16 v[148:151], v[16:19], v[60:63], v[148:151]
  v_mfma_f32_16x16x32_bf16 v[156:159], v[20:23], v[60:63], v[156:159]
  v_mfma_f32_16x16x32_bf16 v[212:215], v[24:27], v[60:63], v[212:215]
  v_mfma_f32_16x16x32_bf16 v[220:223], v[28:31], v[60:63], v[220:223]
  s_waitcnt lgkmcnt(0)
  v_mfma_f32_16x16x32_bf16 v[160:163], v[16:19], v[64:67], v[160:163]
  s_barrier
  v_mfma_f32_16x16x32_bf16 v[168:171], v[20:23], v[64:67], v[168:171]
  ds_read_b128 v[56:59], v9 offset:0
  ds_read_b64_tr_b16 v[32:33], v12 offset:49152
  v_mfma_f32_16x16x32_bf16 v[224:227], v[24:27], v[64:67], v[224:227]
  ds_read_b64_tr_b16 v[34:35], v12 offset:50176
  v_mfma_f32_16x16x32_bf16 v[232:235], v[28:31], v[64:67], v[232:235]
  ds_read_b64_tr_b16 v[36:37], v12 offset:57344
  v_mfma_f32_16x16x32_bf16 v[164:167], v[16:19], v[68:71], v[164:167]
  ds_read_b128 v[60:63], v9 offset:2048
  v_mfma_f32_16x16x32_bf16 v[172:175], v[20:23], v[68:71], v[172:175]
  ds_read_b64_tr_b16 v[38:39], v12 offset:58368
  v_mfma_f32_16x16x32_bf16 v[228:231], v[24:27], v[68:71], v[228:231]
  ds_read_b64_tr_b16 v[40:41], v13 offset:49152
  v_mfma_f32_16x16x32_bf16 v[236:239], v[28:31], v[68:71], v[236:239]
  ds_read_b64_tr_b16 v[42:43], v13 offset:50176
  v_mfma_f32_16x16x32_bf16 v[176:179], v[16:19], v[48:51], v[176:179]
  ds_read_b128 v[64:67], v9 offset:4096
  v_mfma_f32_16x16x32_bf16 v[184:187], v[20:23], v[48:51], v[184:187]
  ds_read_b64_tr_b16 v[44:45], v13 offset:57344
  v_mfma_f32_16x16x32_bf16 v[240:243], v[24:27], v[48:51], v[240:243]
  ds_read_b64_tr_b16 v[46:47], v13 offset:58368
  v_mfma_f32_16x16x32_bf16 v[248:251], v[28:31], v[48:51], v[248:251]
  v_mfma_f32_16x16x32_bf16 v[180:183], v[16:19], v[52:55], v[180:183]
  ds_read_b128 v[68:71], v9 offset:6144
  v_mfma_f32_16x16x32_bf16 v[188:191], v[20:23], v[52:55], v[188:191]
  v_mfma_f32_16x16x32_bf16 v[244:247], v[24:27], v[52:55], v[244:247]
  v_mfma_f32_16x16x32_bf16 v[252:255], v[28:31], v[52:55], v[252:255]
  s_waitcnt lgkmcnt(1)
  v_mfma_f32_16x16x32_bf16 v[128:131], v[32:35], v[56:59], v[128:131]
  ds_read_b128 v[48:51], v9 offset:8192
  v_mfma_f32_16x16x32_bf16 v[136:139], v[36:39], v[56:59], v[136:139]
  v_mfma_f32_16x16x32_bf16 v[192:195], v[40:43], v[56:59], v[192:195]
  v_mfma_f32_16x16x32_bf16 v[200:203], v[44:47], v[56:59], v[200:203]
  v_mfma_f32_16x16x32_bf16 v[132:135], v[32:35], v[60:63], v[132:135]
  ds_read_b128 v[52:55], v9 offset:10240
  v_mfma_f32_16x16x32_bf16 v[140:143], v[36:39], v[60:63], v[140:143]
  v_mfma_f32_16x16x32_bf16 v[196:199], v[40:43], v[60:63], v[196:199]
  v_mfma_f32_16x16x32_bf16 v[204:207], v[44:47], v[60:63], v[204:207]
  v_mfma_f32_16x16x32_bf16 v[144:147], v[32:35], v[64:67], v[144:147]
  ds_read_b128 v[56:59], v9 offset:12288
  v_mfma_f32_16x16x32_bf16 v[152:155], v[36:39], v[64:67], v[152:155]
  ds_read_b128 v[60:63], v9 offset:14336
  v_mfma_f32_16x16x32_bf16 v[208:211], v[40:43], v[64:67], v[208:211]
  v_mfma_f32_16x16x32_bf16 v[216:219], v[44:47], v[64:67], v[216:219]
  s_waitcnt lgkmcnt(4)
  v_mfma_f32_16x16x32_bf16 v[148:151], v[32:35], v[68:71], v[148:151]
  v_mfma_f32_16x16x32_bf16 v[156:159], v[36:39], v[68:71], v[156:159]
  v_mfma_f32_16x16x32_bf16 v[212:215], v[40:43], v[68:71], v[212:215]
  v_mfma_f32_16x16x32_bf16 v[220:223], v[44:47], v[68:71], v[220:223]
  s_waitcnt lgkmcnt(0)
  v_mfma_f32_16x16x32_bf16 v[160:163], v[32:35], v[48:51], v[160:163]
  s_barrier
  v_mfma_f32_16x16x32_bf16 v[168:171], v[36:39], v[48:51], v[168:171]
  ds_read_b128 v[64:67], v8 offset:16384
  ds_read_b64_tr_b16 v[16:17], v12 offset:0
  v_mfma_f32_16x16x32_bf16 v[224:227], v[40:43], v[48:51], v[224:227]
  ds_read_b64_tr_b16 v[18:19], v12 offset:1024
  v_mfma_f32_16x16x32_bf16 v[232:235], v[44:47], v[48:51], v[232:235]
  ds_read_b64_tr_b16 v[20:21], v12 offset:8192
  v_mfma_f32_16x16x32_bf16 v[164:167], v[32:35], v[52:55], v[164:167]
  ds_read_b128 v[68:71], v8 offset:18432
  v_mfma_f32_16x16x32_bf16 v[172:175], v[36:39], v[52:55], v[172:175]
  ds_read_b64_tr_b16 v[22:23], v12 offset:9216
  v_mfma_f32_16x16x32_bf16 v[228:231], v[40:43], v[52:55], v[228:231]
  ds_read_b64_tr_b16 v[24:25], v13 offset:0
  v_mfma_f32_16x16x32_bf16 v[236:239], v[44:47], v[52:55], v[236:239]
  ds_read_b64_tr_b16 v[26:27], v13 offset:1024
  v_mfma_f32_16x16x32_bf16 v[176:179], v[32:35], v[56:59], v[176:179]
  ds_read_b128 v[48:51], v8 offset:20480
  v_mfma_f32_16x16x32_bf16 v[184:187], v[36:39], v[56:59], v[184:187]
  ds_read_b64_tr_b16 v[28:29], v13 offset:8192
  v_mfma_f32_16x16x32_bf16 v[240:243], v[40:43], v[56:59], v[240:243]
  ds_read_b64_tr_b16 v[30:31], v13 offset:9216
  v_mfma_f32_16x16x32_bf16 v[248:251], v[44:47], v[56:59], v[248:251]
  v_mfma_f32_16x16x32_bf16 v[180:183], v[32:35], v[60:63], v[180:183]
  ds_read_b128 v[52:55], v8 offset:22528
  v_mfma_f32_16x16x32_bf16 v[188:191], v[36:39], v[60:63], v[188:191]
  v_mfma_f32_16x16x32_bf16 v[244:247], v[40:43], v[60:63], v[244:247]
  v_mfma_f32_16x16x32_bf16 v[252:255], v[44:47], v[60:63], v[252:255]
  s_waitcnt lgkmcnt(1)
  v_mfma_f32_16x16x32_bf16 v[128:131], v[16:19], v[64:67], v[128:131]
  ds_read_b128 v[56:59], v8 offset:24576
  v_mfma_f32_16x16x32_bf16 v[136:139], v[20:23], v[64:67], v[136:139]
  v_mfma_f32_16x16x32_bf16 v[192:195], v[24:27], v[64:67], v[192:195]
  v_mfma_f32_16x16x32_bf16 v[200:203], v[28:31], v[64:67], v[200:203]
  v_mfma_f32_16x16x32_bf16 v[132:135], v[16:19], v[68:71], v[132:135]
  ds_read_b128 v[60:63], v8 offset:26624
  v_mfma_f32_16x16x32_bf16 v[140:143], v[20:23], v[68:71], v[140:143]
  v_mfma_f32_16x16x32_bf16 v[196:199], v[24:27], v[68:71], v[196:199]
  v_mfma_f32_16x16x32_bf16 v[204:207], v[28:31], v[68:71], v[204:207]
  v_mfma_f32_16x16x32_bf16 v[144:147], v[16:19], v[48:51], v[144:147]
  ds_read_b128 v[64:67], v8 offset:28672
  v_mfma_f32_16x16x32_bf16 v[152:155], v[20:23], v[48:51], v[152:155]
  ds_read_b128 v[68:71], v8 offset:30720
  v_mfma_f32_16x16x32_bf16 v[208:211], v[24:27], v[48:51], v[208:211]
  v_mfma_f32_16x16x32_bf16 v[216:219], v[28:31], v[48:51], v[216:219]
  s_waitcnt lgkmcnt(4)
  v_mfma_f32_16x16x32_bf16 v[148:151], v[16:19], v[52:55], v[148:151]
  v_mfma_f32_16x16x32_bf16 v[156:159], v[20:23], v[52:55], v[156:159]
  v_mfma_f32_16x16x32_bf16 v[212:215], v[24:27], v[52:55], v[212:215]
  v_mfma_f32_16x16x32_bf16 v[220:223], v[28:31], v[52:55], v[220:223]
  s_waitcnt lgkmcnt(3)
  v_mfma_f32_16x16x32_bf16 v[160:163], v[16:19], v[56:59], v[160:163]
  ds_read_b128 v[48:51], v9 offset:16384
  v_mfma_f32_16x16x32_bf16 v[168:171], v[20:23], v[56:59], v[168:171]
  ds_read_b64_tr_b16 v[32:33], v12 offset:16384
  v_mfma_f32_16x16x32_bf16 v[224:227], v[24:27], v[56:59], v[224:227]
  ds_read_b64_tr_b16 v[34:35], v12 offset:17408
  v_mfma_f32_16x16x32_bf16 v[232:235], v[28:31], v[56:59], v[232:235]
  ds_read_b64_tr_b16 v[36:37], v12 offset:24576
  s_waitcnt lgkmcnt(6)
  v_mfma_f32_16x16x32_bf16 v[164:167], v[16:19], v[60:63], v[164:167]
  ds_read_b128 v[52:55], v9 offset:18432
  v_mfma_f32_16x16x32_bf16 v[172:175], v[20:23], v[60:63], v[172:175]
  ds_read_b64_tr_b16 v[38:39], v12 offset:25600
  v_mfma_f32_16x16x32_bf16 v[228:231], v[24:27], v[60:63], v[228:231]
  ds_read_b64_tr_b16 v[40:41], v13 offset:16384
  v_mfma_f32_16x16x32_bf16 v[236:239], v[28:31], v[60:63], v[236:239]
  ds_read_b64_tr_b16 v[42:43], v13 offset:17408
  s_waitcnt lgkmcnt(9)
  v_mfma_f32_16x16x32_bf16 v[176:179], v[16:19], v[64:67], v[176:179]
  ds_read_b128 v[56:59], v9 offset:20480
  v_mfma_f32_16x16x32_bf16 v[184:187], v[20:23], v[64:67], v[184:187]
  ds_read_b64_tr_b16 v[44:45], v13 offset:24576
  v_mfma_f32_16x16x32_bf16 v[240:243], v[24:27], v[64:67], v[240:243]
  ds_read_b64_tr_b16 v[46:47], v13 offset:25600
  v_mfma_f32_16x16x32_bf16 v[248:251], v[28:31], v[64:67], v[248:251]
  s_waitcnt lgkmcnt(11)
  v_mfma_f32_16x16x32_bf16 v[180:183], v[16:19], v[68:71], v[180:183]
  ds_read_b128 v[60:63], v9 offset:22528
  v_mfma_f32_16x16x32_bf16 v[188:191], v[20:23], v[68:71], v[188:191]
  v_mfma_f32_16x16x32_bf16 v[244:247], v[24:27], v[68:71], v[244:247]
  v_mfma_f32_16x16x32_bf16 v[252:255], v[28:31], v[68:71], v[252:255]
  s_waitcnt lgkmcnt(1)
  v_mfma_f32_16x16x32_bf16 v[128:131], v[32:35], v[48:51], v[128:131]
  ds_read_b128 v[64:67], v9 offset:24576
  v_mfma_f32_16x16x32_bf16 v[136:139], v[36:39], v[48:51], v[136:139]
  v_mfma_f32_16x16x32_bf16 v[192:195], v[40:43], v[48:51], v[192:195]
  v_mfma_f32_16x16x32_bf16 v[200:203], v[44:47], v[48:51], v[200:203]
  v_mfma_f32_16x16x32_bf16 v[132:135], v[32:35], v[52:55], v[132:135]
  ds_read_b128 v[68:71], v9 offset:26624
  v_mfma_f32_16x16x32_bf16 v[140:143], v[36:39], v[52:55], v[140:143]
  v_mfma_f32_16x16x32_bf16 v[196:199], v[40:43], v[52:55], v[196:199]
  v_mfma_f32_16x16x32_bf16 v[204:207], v[44:47], v[52:55], v[204:207]
  v_mfma_f32_16x16x32_bf16 v[144:147], v[32:35], v[56:59], v[144:147]
  ds_read_b128 v[48:51], v9 offset:28672
  v_mfma_f32_16x16x32_bf16 v[152:155], v[36:39], v[56:59], v[152:155]
  ds_read_b128 v[52:55], v9 offset:30720
  v_mfma_f32_16x16x32_bf16 v[208:211], v[40:43], v[56:59], v[208:211]
  v_mfma_f32_16x16x32_bf16 v[216:219], v[44:47], v[56:59], v[216:219]
  s_waitcnt lgkmcnt(4)
  v_mfma_f32_16x16x32_bf16 v[148:151], v[32:35], v[60:63], v[148:151]
  v_mfma_f32_16x16x32_bf16 v[156:159], v[36:39], v[60:63], v[156:159]
  v_mfma_f32_16x16x32_bf16 v[212:215], v[40:43], v[60:63], v[212:215]
  v_mfma_f32_16x16x32_bf16 v[220:223], v[44:47], v[60:63], v[220:223]
  s_waitcnt lgkmcnt(0)
  s_waitcnt vmcnt(0)
  v_mfma_f32_16x16x32_bf16 v[160:163], v[32:35], v[64:67], v[160:163]
  v_mov_b32 v4, 163808
  v_mov_b32 v5, 1
  s_mov_b64 exec, 1
  ds_add_u32 v4, v5
  s_mov_b64 exec, -1
  v_lshrrev_b32 v4, 4, v1
  v_mfma_f32_16x16x32_bf16 v[168:171], v[36:39], v[64:67], v[168:171]
  v_and_b32 v5, 15, v1
  v_lshlrev_b32 v5, 4, v5
  v_mfma_f32_16x16x32_bf16 v[224:227], v[40:43], v[64:67], v[224:227]
  v_lshl_add_u32 v120, v4, 9, v5
  v_add_u32 v3, 4096, v120
  v_mfma_f32_16x16x32_bf16 v[232:235], v[44:47], v[64:67], v[232:235]
  v_add_u32 v8, 8192, v120
  v_add_u32 v9, 12288, v120
  v_mfma_f32_16x16x32_bf16 v[164:167], v[32:35], v[68:71], v[164:167]
  v_add_u32 v10, 16384, v120
  v_add_u32 v11, 20480, v120
  v_mfma_f32_16x16x32_bf16 v[172:175], v[36:39], v[68:71], v[172:175]
  v_add_u32 v12, 24576, v120
  v_bfe_u32 v4, v1, 4, 1
  v_mfma_f32_16x16x32_bf16 v[228:231], v[40:43], v[68:71], v[228:231]
  v_lshlrev_b32 v16, 2, v4
  v_and_b32 v5, 7, v1
  v_mfma_f32_16x16x32_bf16 v[236:239], v[44:47], v[68:71], v[236:239]
  v_xor_b32 v16, v16, v5
  v_lshlrev_b32 v16, 4, v16
  v_mfma_f32_16x16x32_bf16 v[176:179], v[32:35], v[48:51], v[176:179]
  v_lshrrev_b32 v5, 3, v1
  v_lshl_add_u32 v16, v5, 10, v16
  v_mfma_f32_16x16x32_bf16 v[184:187], v[36:39], v[48:51], v[184:187]
  v_xor_b32 v126, 32, v16
  v_lshrrev_b32 v4, 5, v1
  v_mfma_f32_16x16x32_bf16 v[240:243], v[40:43], v[48:51], v[240:243]
  v_lshlrev_b32 v17, 11, v4
  v_bfe_u32 v4, v1, 4, 1
  v_mfma_f32_16x16x32_bf16 v[248:251], v[44:47], v[48:51], v[248:251]
  v_bfe_u32 v5, v1, 2, 2
  v_lshl_add_u32 v4, v4, 3, v5
  v_mfma_f32_16x16x32_bf16 v[180:183], v[32:35], v[52:55], v[180:183]
  v_lshl_add_u32 v17, v4, 7, v17
  v_and_b32 v4, 3, v1
  v_mfma_f32_16x16x32_bf16 v[188:191], v[36:39], v[52:55], v[188:191]
  v_lshl_add_u32 v17, v4, 3, v17
  v_lshrrev_b32 v5, 1, v5
  v_mfma_f32_16x16x32_bf16 v[244:247], v[40:43], v[52:55], v[244:247]
  v_lshl_add_u32 v17, v5, 6, v17
  v_bfe_u32 v4, v1, 4, 1
  v_mfma_f32_16x16x32_bf16 v[252:255], v[44:47], v[52:55], v[252:255]
  v_lshl_add_u32 v17, v4, 5, v17
  v_add_u32 v17, s9, v17
  v_xor_b32 v18, 64, v17
  v_add_u32 v14, s9, v2
  s_lshr_b32 s10, s67, 1
  s_lshl_b32 s10, s10, 8
  s_add_u32 s8, s10, 0xe10000
  s_cmp_eq_u32 s3, 0
  s_cselect_b32 s10, 0, 0x2000000
  v_mov_b32 v13, s10
  v_mov_b32 v15, 0
  v_mul_f32 v128, s66, v128
  v_mul_f32 v129, s66, v129
  v_mul_f32 v130, s66, v130
  v_mul_f32 v131, s66, v131
  v_mul_f32 v132, s66, v132
  v_mul_f32 v133, s66, v133
  v_mul_f32 v134, s66, v134
  v_mul_f32 v135, s66, v135
  v_exp_f32 v128, v128
  v_exp_f32 v129, v129
  v_exp_f32 v130, v130
  v_exp_f32 v131, v131
  v_exp_f32 v132, v132
  v_exp_f32 v133, v133
  v_exp_f32 v134, v134
  v_exp_f32 v135, v135
  v_add_f32 v128, 1.0, v128
  v_add_f32 v129, 1.0, v129
  v_add_f32 v130, 1.0, v130
  v_add_f32 v131, 1.0, v131
  v_add_f32 v132, 1.0, v132
  v_add_f32 v133, 1.0, v133
  v_add_f32 v134, 1.0, v134
  v_add_f32 v135, 1.0, v135
  v_rcp_f32 v128, v128
  v_rcp_f32 v129, v129
  v_rcp_f32 v130, v130
  v_rcp_f32 v131, v131
  v_rcp_f32 v132, v132
  v_rcp_f32 v133, v133
  v_rcp_f32 v134, v134
  v_rcp_f32 v135, v135
  v_mul_f32 v128, v128, v136
  v_mul_f32 v129, v129, v137
  v_mul_f32 v130, v130, v138
  v_mul_f32 v131, v131, v139
  v_mul_f32 v132, v132, v140
  v_mul_f32 v133, v133, v141
  v_mul_f32 v134, v134, v142
  v_mul_f32 v135, v135, v143
  v_cvt_pk_bf16_f32 v128, v128, v129
  v_cvt_pk_bf16_f32 v129, v130, v131
  v_cvt_pk_bf16_f32 v130, v132, v133
  v_cvt_pk_bf16_f32 v131, v134, v135
  s_add_u32 s29, s28, 0
  v_permlane16_swap_b32 v128, v130
  v_permlane16_swap_b32 v129, v131
  buffer_store_dwordx4 v[128:131], v2, s[16:19], s29 offen sc1
  v_mul_f32 v144, s66, v144
  v_mul_f32 v145, s66, v145
  v_mul_f32 v146, s66, v146
  v_mul_f32 v147, s66, v147
  v_mul_f32 v148, s66, v148
  v_mul_f32 v149, s66, v149
  v_mul_f32 v150, s66, v150
  v_mul_f32 v151, s66, v151
  v_exp_f32 v144, v144
  v_exp_f32 v145, v145
  v_exp_f32 v146, v146
  v_exp_f32 v147, v147
  v_exp_f32 v148, v148
  v_exp_f32 v149, v149
  v_exp_f32 v150, v150
  v_exp_f32 v151, v151
  v_add_f32 v144, 1.0, v144
  v_add_f32 v145, 1.0, v145
  v_add_f32 v146, 1.0, v146
  v_add_f32 v147, 1.0, v147
  v_add_f32 v148, 1.0, v148
  v_add_f32 v149, 1.0, v149
  v_add_f32 v150, 1.0, v150
  v_add_f32 v151, 1.0, v151
  v_rcp_f32 v144, v144
  v_rcp_f32 v145, v145
  v_rcp_f32 v146, v146
  v_rcp_f32 v147, v147
  v_rcp_f32 v148, v148
  v_rcp_f32 v149, v149
  v_rcp_f32 v150, v150
  v_rcp_f32 v151, v151
  v_mul_f32 v144, v144, v152
  v_mul_f32 v145, v145, v153
  v_mul_f32 v146, v146, v154
  v_mul_f32 v147, v147, v155
  v_mul_f32 v148, v148, v156
  v_mul_f32 v149, v149, v157
  v_mul_f32 v150, v150, v158
  v_mul_f32 v151, v151, v159
  v_cvt_pk_bf16_f32 v144, v144, v145
  v_cvt_pk_bf16_f32 v145, v146, v147
  v_cvt_pk_bf16_f32 v146, v148, v149
  v_cvt_pk_bf16_f32 v147, v150, v151
  s_add_u32 s29, s28, 114688
  v_permlane16_swap_b32 v144, v146
  v_permlane16_swap_b32 v145, v147
  buffer_store_dwordx4 v[144:147], v2, s[16:19], s29 offen sc1
  v_mul_f32 v160, s66, v160
  v_mul_f32 v161, s66, v161
  v_mul_f32 v162, s66, v162
  v_mul_f32 v163, s66, v163
  v_mul_f32 v164, s66, v164
  v_mul_f32 v165, s66, v165
  v_mul_f32 v166, s66, v166
  v_mul_f32 v167, s66, v167
  v_exp_f32 v160, v160
  v_exp_f32 v161, v161
  v_exp_f32 v162, v162
  v_exp_f32 v163, v163
  v_exp_f32 v164, v164
  v_exp_f32 v165, v165
  v_exp_f32 v166, v166
  v_exp_f32 v167, v167
  v_add_f32 v160, 1.0, v160
  v_add_f32 v161, 1.0, v161
  v_add_f32 v162, 1.0, v162
  v_add_f32 v163, 1.0, v163
  v_add_f32 v164, 1.0, v164
  v_add_f32 v165, 1.0, v165
  v_add_f32 v166, 1.0, v166
  v_add_f32 v167, 1.0, v167
  v_rcp_f32 v160, v160
  v_rcp_f32 v161, v161
  v_rcp_f32 v162, v162
  v_rcp_f32 v163, v163
  v_rcp_f32 v164, v164
  v_rcp_f32 v165, v165
  v_rcp_f32 v166, v166
  v_rcp_f32 v167, v167
  v_mul_f32 v160, v160, v168
  v_mul_f32 v161, v161, v169
  v_mul_f32 v162, v162, v170
  v_mul_f32 v163, v163, v171
  v_mul_f32 v164, v164, v172
  v_mul_f32 v165, v165, v173
  v_mul_f32 v166, v166, v174
  v_mul_f32 v167, v167, v175
  v_cvt_pk_bf16_f32 v160, v160, v161
  v_cvt_pk_bf16_f32 v161, v162, v163
  v_cvt_pk_bf16_f32 v162, v164, v165
  v_cvt_pk_bf16_f32 v163, v166, v167
  s_add_u32 s29, s28, 229376
  v_permlane16_swap_b32 v160, v162
  v_permlane16_swap_b32 v161, v163
  buffer_store_dwordx4 v[160:163], v2, s[16:19], s29 offen sc1
  v_mul_f32 v176, s66, v176
  v_mul_f32 v177, s66, v177
  v_mul_f32 v178, s66, v178
  v_mul_f32 v179, s66, v179
  v_mul_f32 v180, s66, v180
  v_mul_f32 v181, s66, v181
  v_mul_f32 v182, s66, v182
  v_mul_f32 v183, s66, v183
  v_exp_f32 v176, v176
  v_exp_f32 v177, v177
  v_exp_f32 v178, v178
  v_exp_f32 v179, v179
  v_exp_f32 v180, v180
  v_exp_f32 v181, v181
  v_exp_f32 v182, v182
  v_exp_f32 v183, v183
  v_add_f32 v176, 1.0, v176
  v_add_f32 v177, 1.0, v177
  v_add_f32 v178, 1.0, v178
  v_add_f32 v179, 1.0, v179
  v_add_f32 v180, 1.0, v180
  v_add_f32 v181, 1.0, v181
  v_add_f32 v182, 1.0, v182
  v_add_f32 v183, 1.0, v183
  v_rcp_f32 v176, v176
  v_rcp_f32 v177, v177
  v_rcp_f32 v178, v178
  v_rcp_f32 v179, v179
  v_rcp_f32 v180, v180
  v_rcp_f32 v181, v181
  v_rcp_f32 v182, v182
  v_rcp_f32 v183, v183
  v_mul_f32 v176, v176, v184
  v_mul_f32 v177, v177, v185
  v_mul_f32 v178, v178, v186
  v_mul_f32 v179, v179, v187
  v_mul_f32 v180, v180, v188
  v_mul_f32 v181, v181, v189
  v_mul_f32 v182, v182, v190
  v_mul_f32 v183, v183, v191
  v_cvt_pk_bf16_f32 v176, v176, v177
  v_cvt_pk_bf16_f32 v177, v178, v179
  v_cvt_pk_bf16_f32 v178, v180, v181
  v_cvt_pk_bf16_f32 v179, v182, v183
  s_add_u32 s29, s28, 344064
  v_permlane16_swap_b32 v176, v178
  v_mov_b32 v4, 163808
  v_mov_b32 v5, 1
  s_mov_b64 exec, 1
  ds_add_u32 v4, v5
  s_mov_b64 exec, -1
  v_permlane16_swap_b32 v177, v179
  buffer_store_dwordx4 v[176:179], v2, s[16:19], s29 offen sc1
  v_mul_f32 v192, s66, v192
  v_mul_f32 v193, s66, v193
  v_mul_f32 v194, s66, v194
  v_mul_f32 v195, s66, v195
  v_mul_f32 v196, s66, v196
  v_mul_f32 v197, s66, v197
  v_mul_f32 v198, s66, v198
  v_mul_f32 v199, s66, v199
  v_exp_f32 v192, v192
  v_exp_f32 v193, v193
  v_exp_f32 v194, v194
  v_exp_f32 v195, v195
  v_exp_f32 v196, v196
  v_exp_f32 v197, v197
  v_exp_f32 v198, v198
  v_exp_f32 v199, v199
  v_add_f32 v192, 1.0, v192
  v_add_f32 v193, 1.0, v193
  v_add_f32 v194, 1.0, v194
  v_add_f32 v195, 1.0, v195
  v_add_f32 v196, 1.0, v196
  v_add_f32 v197, 1.0, v197
  v_add_f32 v198, 1.0, v198
  v_add_f32 v199, 1.0, v199
  v_rcp_f32 v192, v192
  v_rcp_f32 v193, v193
  v_rcp_f32 v194, v194
  v_rcp_f32 v195, v195
  v_rcp_f32 v196, v196
  v_rcp_f32 v197, v197
  v_rcp_f32 v198, v198
  v_rcp_f32 v199, v199
  v_mul_f32 v192, v192, v200
  v_mul_f32 v193, v193, v201
  v_mul_f32 v194, v194, v202
  v_mul_f32 v195, v195, v203
  v_mul_f32 v196, v196, v204
  v_mul_f32 v197, v197, v205
  v_mul_f32 v198, v198, v206
  v_mul_f32 v199, v199, v207
  v_cvt_pk_bf16_f32 v192, v192, v193
  v_cvt_pk_bf16_f32 v193, v194, v195
  v_cvt_pk_bf16_f32 v194, v196, v197
  v_cvt_pk_bf16_f32 v195, v198, v199
  s_add_u32 s29, s28, 14336
  v_permlane16_swap_b32 v192, v194
  v_permlane16_swap_b32 v193, v195
  buffer_store_dwordx4 v[192:195], v2, s[16:19], s29 offen sc1
  v_mul_f32 v208, s66, v208
  v_mul_f32 v209, s66, v209
  v_mul_f32 v210, s66, v210
  v_mul_f32 v211, s66, v211
  v_mul_f32 v212, s66, v212
  v_mul_f32 v213, s66, v213
  v_mul_f32 v214, s66, v214
  v_mul_f32 v215, s66, v215
  v_exp_f32 v208, v208
  v_exp_f32 v209, v209
  v_exp_f32 v210, v210
  v_exp_f32 v211, v211
  v_exp_f32 v212, v212
  v_exp_f32 v213, v213
  v_exp_f32 v214, v214
  v_exp_f32 v215, v215
  v_add_f32 v208, 1.0, v208
  v_add_f32 v209, 1.0, v209
  v_add_f32 v210, 1.0, v210
  v_add_f32 v211, 1.0, v211
  v_add_f32 v212, 1.0, v212
  v_add_f32 v213, 1.0, v213
  v_add_f32 v214, 1.0, v214
  v_add_f32 v215, 1.0, v215
  v_rcp_f32 v208, v208
  v_rcp_f32 v209, v209
  v_rcp_f32 v210, v210
  v_rcp_f32 v211, v211
  v_rcp_f32 v212, v212
  v_rcp_f32 v213, v213
  v_rcp_f32 v214, v214
  v_rcp_f32 v215, v215
  v_mul_f32 v208, v208, v216
  v_mul_f32 v209, v209, v217
  v_mul_f32 v210, v210, v218
  v_mul_f32 v211, v211, v219
  v_mul_f32 v212, v212, v220
  v_mul_f32 v213, v213, v221
  v_mul_f32 v214, v214, v222
  v_mul_f32 v215, v215, v223
  v_cvt_pk_bf16_f32 v208, v208, v209
  v_cvt_pk_bf16_f32 v209, v210, v211
  v_cvt_pk_bf16_f32 v210, v212, v213
  v_cvt_pk_bf16_f32 v211, v214, v215
  s_add_u32 s29, s28, 129024
  v_permlane16_swap_b32 v208, v210
  v_permlane16_swap_b32 v209, v211
  buffer_store_dwordx4 v[208:211], v2, s[16:19], s29 offen sc1
  v_mov_b32 v4, 163792
  s_mov_b32 s76, 0x40000
L30:
  ds_read_b32 v5, v4
  s_waitcnt lgkmcnt(0)
  v_readfirstlane_b32 s10, v5
  s_nop 0
  s_cmp_ge_u32 s10, 32
  s_cbranch_scc1 L31
  s_sleep 2
  s_sub_u32 s76, s76, 1
  s_cbranch_scc0 L30
L31:
  v_mov_b32 v4, 163812
  v_mov_b32 v5, 1
  s_waitcnt vmcnt(2)
  s_mov_b64 exec, 1
  ds_add_rtn_u32 v6, v4, v5
  v_mov_b32 v5, 1
  s_waitcnt lgkmcnt(0)
  v_readfirstlane_b32 s30, v6
  s_nop 0
  s_cmp_eq_u32 s30, s81
  s_cselect_b32 s30, 0, 0x2000000
  v_mov_b32 v4, s30
  buffer_atomic_add v5, v4, s[16:19], s24 offen sc1
  s_mov_b64 exec, -1
  v_mul_f32 v224, s66, v224
  v_mul_f32 v225, s66, v225
  v_mul_f32 v226, s66, v226
  v_mul_f32 v227, s66, v227
  v_mul_f32 v228, s66, v228
  v_mul_f32 v229, s66, v229
  v_mul_f32 v230, s66, v230
  v_mul_f32 v231, s66, v231
  v_exp_f32 v224, v224
  v_exp_f32 v225, v225
  v_exp_f32 v226, v226
  v_exp_f32 v227, v227
  v_exp_f32 v228, v228
  v_exp_f32 v229, v229
  v_exp_f32 v230, v230
  v_exp_f32 v231, v231
  v_add_f32 v224, 1.0, v224
  v_add_f32 v225, 1.0, v225
  v_add_f32 v226, 1.0, v226
  v_add_f32 v227, 1.0, v227
  v_add_f32 v228, 1.0, v228
  v_add_f32 v229, 1.0, v229
  v_add_f32 v230, 1.0, v230
  v_add_f32 v231, 1.0, v231
  v_rcp_f32 v224, v224
  v_rcp_f32 v225, v225
  v_rcp_f32 v226, v226
  v_rcp_f32 v227, v227
  v_rcp_f32 v228, v228
  v_rcp_f32 v229, v229
  v_rcp_f32 v230, v230
  v_rcp_f32 v231, v231
  v_mul_f32 v224, v224, v232
  v_mul_f32 v225, v225, v233
  v_mul_f32 v226, v226, v234
  v_mul_f32 v227, v227, v235
  v_mul_f32 v228, v228, v236
  v_mul_f32 v229, v229, v237
  v_mul_f32 v230, v230, v238
  v_mul_f32 v231, v231, v239
  v_cvt_pk_bf16_f32 v224, v224, v225
  v_cvt_pk_bf16_f32 v225, v226, v227
  v_cvt_pk_bf16_f32 v226, v228, v229
  v_cvt_pk_bf16_f32 v227, v230, v231
  s_add_u32 s29, s28, 243712
  v_permlane16_swap_b32 v224, v226
  v_permlane16_swap_b32 v225, v227
  buffer_store_dwordx4 v[224:227], v2, s[16:19], s29 offen sc1
  v_mul_f32 v240, s66, v240
  v_mul_f32 v241, s66, v241
  v_mul_f32 v242, s66, v242
  v_mul_f32 v243, s66, v243
  v_mul_f32 v244, s66, v244
  v_mul_f32 v245, s66, v245
  v_mul_f32 v246, s66, v246
  v_mul_f32 v247, s66, v247
  v_exp_f32 v240, v240
  v_exp_f32 v241, v241
  v_exp_f32 v242, v242
  v_exp_f32 v243, v243
  v_exp_f32 v244, v244
  v_exp_f32 v245, v245
  v_exp_f32 v246, v246
  v_exp_f32 v247, v247
  v_add_f32 v240, 1.0, v240
  v_add_f32 v241, 1.0, v241
  v_add_f32 v242, 1.0, v242
  v_add_f32 v243, 1.0, v243
  v_add_f32 v244, 1.0, v244
  v_add_f32 v245, 1.0, v245
  v_add_f32 v246, 1.0, v246
  v_add_f32 v247, 1.0, v247
  v_rcp_f32 v240, v240
  v_rcp_f32 v241, v241
  v_rcp_f32 v242, v242
  v_rcp_f32 v243, v243
  v_rcp_f32 v244, v244
  v_rcp_f32 v245, v245
  v_rcp_f32 v246, v246
  v_rcp_f32 v247, v247
  v_mul_f32 v240, v240, v248
  v_mul_f32 v241, v241, v249
  v_mul_f32 v242, v242, v250
  v_mul_f32 v243, v243, v251
  v_mul_f32 v244, v244, v252
  v_mul_f32 v245, v245, v253
  v_mov_b32 v15, 0
  s_mov_b64 exec, 1
  buffer_atomic_add v15, v13, s[16:19], s8 offen sc0 sc1
  s_mov_b64 exec, -1
  v_mul_f32 v246, v246, v254
  v_mul_f32 v247, v247, v255
  v_cvt_pk_bf16_f32 v240, v240, v241
  v_cvt_pk_bf16_f32 v241, v242, v243
  v_cvt_pk_bf16_f32 v242, v244, v245
  v_cvt_pk_bf16_f32 v243, v246, v247
  s_add_u32 s29, s28, 358400
  v_permlane16_swap_b32 v240, v242
  v_permlane16_swap_b32 v241, v243
  buffer_store_dwordx4 v[240:243], v2, s[16:19], s29 offen sc1
  s_setprio 0
  s_waitcnt vmcnt(1)
  v_mov_b32 v19, 163816
  v_readfirstlane_b32 s11, v15
  s_nop 0
  s_and_b32 s10, s11, 0xffff
  s_cmp_ge_u32 s10, 14
  s_cbranch_scc0 C_NG
  v_mov_b32 v5, 1
  ds_write_b32 v19, v5
C_NG:
  v_mov_b32 v4, 163820
  v_mov_b32 v5, 1
  s_waitcnt vmcnt(0)
  s_mov_b64 exec, 1
  ds_add_rtn_u32 v6, v4, v5
  ds_read_b32 v7, v19
  v_mov_b32 v5, 65536
  s_waitcnt lgkmcnt(0)
  v_readfirstlane_b32 s30, v6
  s_nop 0
  s_cmp_eq_u32 s30, s81
  s_cselect_b32 s30, 0, 0x2000000
  v_mov_b32 v4, s30
  buffer_atomic_add v5, v4, s[16:19], s24 offen sc1
  s_mov_b64 exec, -1
  v_readfirstlane_b32 s10, v7
P2_START:
  v_mov_b32 v19, 163816
  s_cmp_ge_u32 s10, 1
  s_cbranch_scc0 P2_SLOW
P2_GO:
  buffer_load_dwordx4 v[128:131], v120, s[16:19], s70 offen offset:0 sc1
  buffer_load_dwordx4 v[132:135], v120, s[16:19], s71 offen offset:0 sc1
  buffer_load_dwordx4 v[136:139], v120, s[16:19], s74 offen offset:0 sc1
  buffer_load_dwordx4 v[140:143], v120, s[16:19], s75 offen offset:0 sc1
  buffer_load_dwordx4 v[144:147], v120, s[16:19], s70 offen offset:2048 sc1
  buffer_load_dwordx4 v[148:151], v120, s[16:19], s71 offen offset:2048 sc1
  buffer_load_dwordx4 v[152:155], v120, s[16:19], s74 offen offset:2048 sc1
  buffer_load_dwordx4 v[156:159], v120, s[16:19], s75 offen offset:2048 sc1
  v_mov_b32 v15, 0
  s_mov_b64 exec, 1
  buffer_atomic_add v15, v13, s[16:19], s8 offen sc0 sc1
  s_mov_b64 exec, -1
  buffer_load_dwordx4 v[160:163], v3, s[16:19], s70 offen offset:0 sc1
  buffer_load_dwordx4 v[164:167], v3, s[16:19], s71 offen offset:0 sc1
  buffer_load_dwordx4 v[168:171], v3, s[16:19], s74 offen offset:0 sc1
  buffer_load_dwordx4 v[172:175], v3, s[16:19], s75 offen offset:0 sc1
  buffer_load_dwordx4 v[176:179], v3, s[16:19], s70 offen offset:2048 sc1
  buffer_load_dwordx4 v[180:183], v3, s[16:19], s71 offen offset:2048 sc1
  buffer_load_dwordx4 v[184:187], v3, s[16:19], s74 offen offset:2048 sc1
  buffer_load_dwordx4 v[188:191], v3, s[16:19], s75 offen offset:2048 sc1
  s_mov_b32 s10, 131072
  s_cmp_eq_u32 s13, 0
  s_cselect_b32 s10, s10, 98304
  s_mul_i32 s11, s12, 12288
  s_add_u32 s10, s10, s11
  s_sub_u32 s77, s10, s9
  v_xor_b32 v6, 32, v17
  v_xor_b32 v7, 32, v18
  s_lshl_b32 s10, s3, 2
  s_add_u32 s10, s10, 163776
  v_mov_b32 v4, s10
  s_waitcnt vmcnt(16)
  v_mfma_f32_16x16x32_bf16 v[192:195], v[72:75], v[128:131], 0
  buffer_load_dwordx4 v[24:27], v8, s[16:19], s70 offen offset:0 sc1
  v_mfma_f32_16x16x32_bf16 v[196:199], v[76:79], v[128:131], 0
  v_mfma_f32_16x16x32_bf16 v[200:203], v[80:83], v[128:131], 0
  v_mfma_f32_16x16x32_bf16 v[204:207], v[84:87], v[128:131], 0
  s_waitcnt vmcnt(16)
  v_mfma_f32_16x16x32_bf16 v[208:211], v[72:75], v[132:135], 0
  buffer_load_dwordx4 v[28:31], v8, s[16:19], s71 offen offset:0 sc1
  v_mfma_f32_16x16x32_bf16 v[212:215], v[76:79], v[132:135], 0
  v_mfma_f32_16x16x32_bf16 v[216:219], v[80:83], v[132:135], 0
  v_mfma_f32_16x16x32_bf16 v[220:223], v[84:87], v[132:135], 0
  s_waitcnt vmcnt(16)
  v_mfma_f32_16x16x32_bf16 v[224:227], v[72:75], v[136:139], 0
  buffer_load_dwordx4 v[32:35], v8, s[16:19], s74 offen offset:0 sc1
  v_mfma_f32_16x16x32_bf16 v[228:231], v[76:79], v[136:139], 0
  v_mfma_f32_16x16x32_bf16 v[232:235], v[80:83], v[136:139], 0
  v_mfma_f32_16x16x32_bf16 v[236:239], v[84:87], v[136:139], 0
  ds_read_b32 v123, v4
  s_waitcnt vmcnt(16)
  v_mfma_f32_16x16x32_bf16 v[240:243], v[72:75], v[140:143], 0
  buffer_load_dwordx4 v[36:39], v8, s[16:19], s75 offen offset:0 sc1
  v_mfma_f32_16x16x32_bf16 v[244:247], v[76:79], v[140:143], 0
  v_mfma_f32_16x16x32_bf16 v[248:251], v[80:83], v[140:143], 0
  v_mfma_f32_16x16x32_bf16 v[252:255], v[84:87], v[140:143], 0
  s_waitcnt lgkmcnt(0)
  s_waitcnt vmcnt(16)
  v_mfma_f32_16x16x32_bf16 v[192:195], v[88:91], v[144:147], v[192:195]
  v_readfirstlane_b32 s10, v123
  s_nop 0
  s_cmp_ge_u32 s10, 1
  s_cbranch_scc0 L36o
L36:
  v_mfma_f32_16x16x32_bf16 v[196:199], v[92:95], v[144:147], v[196:199]
  buffer_load_dwordx4 v[40:43], v8, s[16:19], s70 offen offset:2048 sc1
  ds_read_b64_tr_b16 v[56:57], v17 offset:0
  v_mfma_f32_16x16x32_bf16 v[200:203], v[96:99], v[144:147], v[200:203]
  ds_read_b64_tr_b16 v[58:59], v17 offset:512
  v_mfma_f32_16x16x32_bf16 v[204:207], v[100:103], v[144:147], v[204:207]
  ds_read_b64_tr_b16 v[60:61], v6 offset:0
  s_waitcnt vmcnt(16)
  v_mfma_f32_16x16x32_bf16 v[208:211], v[88:91], v[148:151], v[208:211]
  buffer_load_dwordx4 v[44:47], v8, s[16:19], s71 offen offset:2048 sc1
  ds_read_b64_tr_b16 v[62:63], v6 offset:512
  v_mfma_f32_16x16x32_bf16 v[212:215], v[92:95], v[148:151], v[212:215]
  ds_read_b64_tr_b16 v[64:65], v18 offset:0
  v_mfma_f32_16x16x32_bf16 v[216:219], v[96:99], v[148:151], v[216:219]
  ds_read_b64_tr_b16 v[66:67], v18 offset:512
  v_mfma_f32_16x16x32_bf16 v[220:223], v[100:103], v[148:151], v[220:223]
  ds_read_b64_tr_b16 v[68:69], v7 offset:0
  s_waitcnt vmcnt(16)
  v_mfma_f32_16x16x32_bf16 v[224:227], v[88:91], v[152:155], v[224:227]
  buffer_load_dwordx4 v[48:51], v8, s[16:19], s74 offen offset:2048 sc1
  ds_read_b64_tr_b16 v[70:71], v7 offset:512
  v_mfma_f32_16x16x32_bf16 v[228:231], v[92:95], v[152:155], v[228:231]
  v_mfma_f32_16x16x32_bf16 v[232:235], v[96:99], v[152:155], v[232:235]
  v_mfma_f32_16x16x32_bf16 v[236:239], v[100:103], v[152:155], v[236:239]
  ds_read_b32 v123, v4
  s_waitcnt vmcnt(16)
  v_mfma_f32_16x16x32_bf16 v[240:243], v[88:91], v[156:159], v[240:243]
  buffer_load_dwordx4 v[52:55], v8, s[16:19], s75 offen offset:2048 sc1
  v_mfma_f32_16x16x32_bf16 v[244:247], v[92:95], v[156:159], v[244:247]
  v_mfma_f32_16x16x32_bf16 v[248:251], v[96:99], v[156:159], v[248:251]
  v_mfma_f32_16x16x32_bf16 v[252:255], v[100:103], v[156:159], v[252:255]
  s_waitcnt vmcnt(16) lgkmcnt(0)
  s_waitcnt vmcnt(15)
  v_mfma_f32_16x16x32_bf16 v[192:195], v[104:107], v[160:163], v[192:195]
  v_mov_b32 v124, 1
  v_subrev_u32 v125, 16, v4
  ds_write_b32 v125, v124
  v_mfma_f32_16x16x32_bf16 v[196:199], v[108:111], v[160:163], v[196:199]
  s_cmp_eq_u32 s3, 0
  s_cbranch_scc1 P2_B0
P2_B0R:
  v_mfma_f32_16x16x32_bf16 v[200:203], v[112:115], v[160:163], v[200:203]
  buffer_load_dwordx4 v[128:131], v9, s[16:19], s70 offen offset:0 sc1
  ds_read_b64_tr_b16 v[72:73], v17 offset:4096
  v_mfma_f32_16x16x32_bf16 v[204:207], v[116:119], v[160:163], v[204:207]
  ds_read_b64_tr_b16 v[74:75], v17 offset:4608
  s_waitcnt vmcnt(15)
  v_mfma_f32_16x16x32_bf16 v[208:211], v[104:107], v[164:167], v[208:211]
  ds_read_b64_tr_b16 v[76:77], v6 offset:4096
  v_mfma_f32_16x16x32_bf16 v[212:215], v[108:111], v[164:167], v[212:215]
  buffer_load_dwordx4 v[132:135], v9, s[16:19], s71 offen offset:0 sc1
  ds_read_b64_tr_b16 v[78:79], v6 offset:4608
  v_mfma_f32_16x16x32_bf16 v[216:219], v[112:115], v[164:167], v[216:219]
  ds_read_b64_tr_b16 v[80:81], v18 offset:4096
  v_mfma_f32_16x16x32_bf16 v[220:223], v[116:119], v[164:167], v[220:223]
  ds_read_b64_tr_b16 v[82:83], v18 offset:4608
  s_waitcnt vmcnt(15)
  v_mfma_f32_16x16x32_bf16 v[224:227], v[104:107], v[168:171], v[224:227]
  ds_read_b64_tr_b16 v[84:85], v7 offset:4096
  v_mfma_f32_16x16x32_bf16 v[228:231], v[108:111], v[168:171], v[228:231]
  buffer_load_dwordx4 v[136:139], v9, s[16:19], s74 offen offset:0 sc1
  ds_read_b64_tr_b16 v[86:87], v7 offset:4608
  v_mfma_f32_16x16x32_bf16 v[232:235], v[112:115], v[168:171], v[232:235]
  v_mfma_f32_16x16x32_bf16 v[236:239], v[116:119], v[168:171], v[236:239]
  ds_read_b32 v123, v4
  s_waitcnt vmcnt(15)
  v_mfma_f32_16x16x32_bf16 v[240:243], v[104:107], v[172:175], v[240:243]
  ds_read_b32 v5, v19
  buffer_load_dwordx4 v[140:143], v9, s[16:19], s75 offen offset:0 sc1
  v_mfma_f32_16x16x32_bf16 v[244:247], v[108:111], v[172:175], v[244:247]
  v_mfma_f32_16x16x32_bf16 v[248:251], v[112:115], v[172:175], v[248:251]
  v_mfma_f32_16x16x32_bf16 v[252:255], v[116:119], v[172:175], v[252:255]
  s_waitcnt lgkmcnt(0)
  s_waitcnt vmcnt(15)
  v_mfma_f32_16x16x32_bf16 v[192:195], v[56:59], v[176:179], v[192:195]
  v_mov_b32 v124, 2
  v_subrev_u32 v125, 16, v4
  ds_write_b32 v125, v124
  v_mfma_f32_16x16x32_bf16 v[196:199], v[60:63], v[176:179], v[196:199]
  v_readfirstlane_b32 s10, v5
  s_nop 0
  s_cmp_ge_u32 s10, 2
  s_cbranch_scc0 P2_B1
P2_B1R:
  v_mfma_f32_16x16x32_bf16 v[200:203], v[64:67], v[176:179], v[200:203]
  buffer_load_dwordx4 v[144:147], v9, s[16:19], s70 offen offset:2048 sc1
  ds_read_b64_tr_b16 v[88:89], v17 offset:8192
  v_mfma_f32_16x16x32_bf16 v[204:207], v[68:71], v[176:179], v[204:207]
  ds_read_b64_tr_b16 v[90:91], v17 offset:8704
  s_waitcnt vmcnt(15)
  v_mfma_f32_16x16x32_bf16 v[208:211], v[56:59], v[180:183], v[208:211]
  ds_read_b64_tr_b16 v[92:93], v6 offset:8192
  v_mfma_f32_16x16x32_bf16 v[212:215], v[60:63], v[180:183], v[212:215]
  buffer_load_dwordx4 v[148:151], v9, s[16:19], s71 offen offset:2048 sc1
  ds_read_b64_tr_b16 v[94:95], v6 offset:8704
  v_mfma_f32_16x16x32_bf16 v[216:219], v[64:67], v[180:183], v[216:219]
  ds_read_b64_tr_b16 v[96:97], v18 offset:8192
  v_mfma_f32_16x16x32_bf16 v[220:223], v[68:71], v[180:183], v[220:223]
  ds_read_b64_tr_b16 v[98:99], v18 offset:8704
  s_waitcnt vmcnt(15)
  v_mfma_f32_16x16x32_bf16 v[224:227], v[56:59], v[184:187], v[224:227]
  ds_read_b64_tr_b16 v[100:101], v7 offset:8192
  v_mfma_f32_16x16x32_bf16 v[228:231], v[60:63], v[184:187], v[228:231]
  buffer_load_dwordx4 v[152:155], v9, s[16:19], s74 offen offset:2048 sc1
  ds_read_b64_tr_b16 v[102:103], v7 offset:8704
  v_mfma_f32_16x16x32_bf16 v[232:235], v[64:67], v[184:187], v[232:235]
  v_mfma_f32_16x16x32_bf16 v[236:239], v[68:71], v[184:187], v[236:239]
  ds_read_b32 v123, v4
  s_waitcnt vmcnt(15)
  v_mfma_f32_16x16x32_bf16 v[240:243], v[56:59], v[188:191], v[240:243]
  buffer_load_dwordx4 v[156:159], v9, s[16:19], s75 offen offset:2048 sc1
  v_mfma_f32_16x16x32_bf16 v[244:247], v[60:63], v[188:191], v[244:247]
  v_mfma_f32_16x16x32_bf16 v[248:251], v[64:67], v[188:191], v[248:251]
  v_mfma_f32_16x16x32_bf16 v[252:255], v[68:71], v[188:191], v[252:255]
  s_waitcnt lgkmcnt(0)
  s_waitcnt vmcnt(15)
  v_mfma_f32_16x16x32_bf16 v[192:195], v[72:75], v[24:27], v[192:195]
  v_mov_b32 v124, 3
  v_subrev_u32 v125, 16, v4
  ds_write_b32 v125, v124
  v_mfma_f32_16x16x32_bf16 v[196:199], v[76:79], v[24:27], v[196:199]
  buffer_load_dwordx4 v[160:163], v10, s[16:19], s70 offen offset:0 sc1
  ds_read_b64_tr_b16 v[104:105], v17 offset:12288
  v_mfma_f32_16x16x32_bf16 v[200:203], v[80:83], v[24:27], v[200:203]
  ds_read_b64_tr_b16 v[106:107], v17 offset:12800
  v_mfma_f32_16x16x32_bf16 v[204:207], v[84:87], v[24:27], v[204:207]
  ds_read_b64_tr_b16 v[108:109], v6 offset:12288
  s_waitcnt vmcnt(15)
  v_mfma_f32_16x16x32_bf16 v[208:211], v[72:75], v[28:31], v[208:211]
  buffer_load_dwordx4 v[164:167], v10, s[16:19], s71 offen offset:0 sc1
  ds_read_b64_tr_b16 v[110:111], v6 offset:12800
  v_mfma_f32_16x16x32_bf16 v[212:215], v[76:79], v[28:31], v[212:215]
  ds_read_b64_tr_b16 v[112:113], v18 offset:12288
  v_mfma_f32_16x16x32_bf16 v[216:219], v[80:83], v[28:31], v[216:219]
  ds_read_b64_tr_b16 v[114:115], v18 offset:12800
  v_mfma_f32_16x16x32_bf16 v[220:223], v[84:87], v[28:31], v[220:223]
  ds_read_b64_tr_b16 v[116:117], v7 offset:12288
  s_waitcnt vmcnt(15)
  v_mfma_f32_16x16x32_bf16 v[224:227], v[72:75], v[32:35], v[224:227]
  buffer_load_dwordx4 v[168:171], v10, s[16:19], s74 offen offset:0 sc1
  ds_read_b64_tr_b16 v[118:119], v7 offset:12800
  v_mfma_f32_16x16x32_bf16 v[228:231], v[76:79], v[32:35], v[228:231]
  v_mfma_f32_16x16x32_bf16 v[232:235], v[80:83], v[32:35], v[232:235]
  v_mfma_f32_16x16x32_bf16 v[236:239], v[84:87], v[32:35], v[236:239]
  ds_read_b32 v123, v4
  s_waitcnt vmcnt(15)
  v_mfma_f32_16x16x32_bf16 v[240:243], v[72:75], v[36:39], v[240:243]
  buffer_load_dwordx4 v[172:175], v10, s[16:19], s75 offen offset:0 sc1
  v_mfma_f32_16x16x32_bf16 v[244:247], v[76:79], v[36:39], v[244:247]
  v_mfma_f32_16x16x32_bf16 v[248:251], v[80:83], v[36:39], v[248:251]
  v_mfma_f32_16x16x32_bf16 v[252:255], v[84:87], v[36:39], v[252:255]
  s_waitcnt lgkmcnt(0)
  s_waitcnt vmcnt(15)
  v_mfma_f32_16x16x32_bf16 v[192:195], v[88:91], v[40:43], v[192:195]
  buffer_load_dwordx4 v[176:179], v10, s[16:19], s70 offen offset:2048 sc1
  ds_read_b64_tr_b16 v[56:57], v17 offset:16384
  v_mfma_f32_16x16x32_bf16 v[196:199], v[92:95], v[40:43], v[196:199]
  ds_read_b64_tr_b16 v[58:59], v17 offset:16896
  v_mfma_f32_16x16x32_bf16 v[200:203], v[96:99], v[40:43], v[200:203]
  ds_read_b64_tr_b16 v[60:61], v6 offset:16384
  v_mfma_f32_16x16x32_bf16 v[204:207], v[100:103], v[40:43], v[204:207]
  buffer_load_dwordx4 v[180:183], v10, s[16:19], s71 offen offset:2048 sc1
  ds_read_b64_tr_b16 v[62:63], v6 offset:16896
  s_waitcnt vmcnt(16)
  v_mfma_f32_16x16x32_bf16 v[208:211], v[88:91], v[44:47], v[208:211]
  ds_read_b64_tr_b16 v[64:65], v18 offset:16384
  v_mfma_f32_16x16x32_bf16 v[212:215], v[92:95], v[44:47], v[212:215]
  ds_read_b64_tr_b16 v[66:67], v18 offset:16896
  v_mfma_f32_16x16x32_bf16 v[216:219], v[96:99], v[44:47], v[216:219]
  buffer_load_dwordx4 v[184:187], v10, s[16:19], s74 offen offset:2048 sc1
  ds_read_b64_tr_b16 v[68:69], v7 offset:16384
  v_mfma_f32_16x16x32_bf16 v[220:223], v[100:103], v[44:47], v[220:223]
  ds_read_b64_tr_b16 v[70:71], v7 offset:16896
  s_waitcnt vmcnt(16)
  v_mfma_f32_16x16x32_bf16 v[224:227], v[88:91], v[48:51], v[224:227]
  v_mfma_f32_16x16x32_bf16 v[228:231], v[92:95], v[48:51], v[228:231]
  buffer_load_dwordx4 v[188:191], v10, s[16:19], s75 offen offset:2048 sc1
  v_mfma_f32_16x16x32_bf16 v[232:235], v[96:99], v[48:51], v[232:235]
  v_mfma_f32_16x16x32_bf16 v[236:239], v[100:103], v[48:51], v[236:239]
  ds_read_b32 v123, v4
  s_waitcnt vmcnt(16)
  v_mfma_f32_16x16x32_bf16 v[240:243], v[88:91], v[52:55], v[240:243]
  v_and_b32 v15, 15, v1
  v_lshlrev_b32 v13, 2, v15
  s_add_u32 s10, s15, 0
  buffer_load_dword v20, v13, s[16:19], s10 offen sc1
  s_add_u32 s10, s15, 8192
  buffer_load_dword v21, v13, s[16:19], s10 offen sc1
  s_add_u32 s10, s15, 16384
  buffer_load_dword v22, v13, s[16:19], s10 offen sc1
  s_add_u32 s10, s15, 24576
  buffer_load_dword v23, v13, s[16:19], s10 offen sc1
  v_mfma_f32_16x16x32_bf16 v[244:247], v[92:95], v[52:55], v[244:247]
  v_mfma_f32_16x16x32_bf16 v[248:251], v[96:99], v[52:55], v[248:251]
  v_mfma_f32_16x16x32_bf16 v[252:255], v[100:103], v[52:55], v[252:255]
  s_waitcnt lgkmcnt(0)
  s_waitcnt vmcnt(19)
  v_mfma_f32_16x16x32_bf16 v[192:195], v[104:107], v[128:131], v[192:195]
  v_readfirstlane_b32 s10, v123
  s_nop 0
  s_cmp_ge_u32 s10, 2
  s_cbranch_scc0 L39o
L39:
  v_add_u32 v17, s77, v17
  v_add_u32 v6, s77, v6
  v_add_u32 v18, s77, v18
  v_add_u32 v7, s77, v7
  v_mfma_f32_16x16x32_bf16 v[196:199], v[108:111], v[128:131], v[196:199]
  buffer_load_dwordx4 v[24:27], v11, s[16:19], s70 offen offset:0 sc1
  ds_read_b64_tr_b16 v[72:73], v17 offset:0
  v_mfma_f32_16x16x32_bf16 v[200:203], v[112:115], v[128:131], v[200:203]
  ds_read_b64_tr_b16 v[74:75], v17 offset:512
  v_mfma_f32_16x16x32_bf16 v[204:207], v[116:119], v[128:131], v[204:207]
  ds_read_b64_tr_b16 v[76:77], v6 offset:0
  s_waitcnt vmcnt(19)
  v_mfma_f32_16x16x32_bf16 v[208:211], v[104:107], v[132:135], v[208:211]
  buffer_load_dwordx4 v[28:31], v11, s[16:19], s71 offen offset:0 sc1
  ds_read_b64_tr_b16 v[78:79], v6 offset:512
  v_mfma_f32_16x16x32_bf16 v[212:215], v[108:111], v[132:135], v[212:215]
  ds_read_b64_tr_b16 v[80:81], v18 offset:0
  v_mfma_f32_16x16x32_bf16 v[216:219], v[112:115], v[132:135], v[216:219]
  ds_read_b64_tr_b16 v[82:83], v18 offset:512
  v_mfma_f32_16x16x32_bf16 v[220:223], v[116:119], v[132:135], v[220:223]
  ds_read_b64_tr_b16 v[84:85], v7 offset:0
  s_waitcnt vmcnt(19)
  v_mfma_f32_16x16x32_bf16 v[224:227], v[104:107], v[136:139], v[224:227]
  buffer_load_dwordx4 v[32:35], v11, s[16:19], s74 offen offset:0 sc1
  ds_read_b64_tr_b16 v[86:87], v7 offset:512
  v_mfma_f32_16x16x32_bf16 v[228:231], v[108:111], v[136:139], v[228:231]
  v_mfma_f32_16x16x32_bf16 v[232:235], v[112:115], v[136:139], v[232:235]
  v_mfma_f32_16x16x32_bf16 v[236:239], v[116:119], v[136:139], v[236:239]
  ds_read_b32 v123, v4
  s_waitcnt vmcnt(19)
  v_mfma_f32_16x16x32_bf16 v[240:243], v[104:107], v[140:143], v[240:243]
  buffer_load_dwordx4 v[36:39], v11, s[16:19], s75 offen offset:0 sc1
  v_mfma_f32_16x16x32_bf16 v[244:247], v[108:111], v[140:143], v[244:247]
  v_mfma_f32_16x16x32_bf16 v[248:251], v[112:115], v[140:143], v[248:251]
  v_mfma_f32_16x16x32_bf16 v[252:255], v[116:119], v[140:143], v[252:255]
  s_waitcnt lgkmcnt(0)
  s_waitcnt vmcnt(19)
  v_mfma_f32_16x16x32_bf16 v[192:195], v[56:59], v[144:147], v[192:195]
  v_readfirstlane_b32 s10, v123
  s_nop 0
  s_cmp_ge_u32 s10, 3
  s_cbranch_scc0 L42o
L42:
  v_mfma_f32_16x16x32_bf16 v[196:199], v[60:63], v[144:147], v[196:199]
  buffer_load_dwordx4 v[40:43], v11, s[16:19], s70 offen offset:2048 sc1
  ds_read_b64_tr_b16 v[88:89], v17 offset:4096
  v_mfma_f32_16x16x32_bf16 v[200:203], v[64:67], v[144:147], v[200:203]
  ds_read_b64_tr_b16 v[90:91], v17 offset:4608
  v_mfma_f32_16x16x32_bf16 v[204:207], v[68:71], v[144:147], v[204:207]
  ds_read_b64_tr_b16 v[92:93], v6 offset:4096
  s_waitcnt vmcnt(19)
  v_mfma_f32_16x16x32_bf16 v[208:211], v[56:59], v[148:151], v[208:211]
  buffer_load_dwordx4 v[44:47], v11, s[16:19], s71 offen offset:2048 sc1
  ds_read_b64_tr_b16 v[94:95], v6 offset:4608
  v_mfma_f32_16x16x32_bf16 v[212:215], v[60:63], v[148:151], v[212:215]
  ds_read_b64_tr_b16 v[96:97], v18 offset:4096
  v_mfma_f32_16x16x32_bf16 v[216:219], v[64:67], v[148:151], v[216:219]
  ds_read_b64_tr_b16 v[98:99], v18 offset:4608
  v_mfma_f32_16x16x32_bf16 v[220:223], v[68:71], v[148:151], v[220:223]
  ds_read_b64_tr_b16 v[100:101], v7 offset:4096
  s_waitcnt vmcnt(19)
  v_mfma_f32_16x16x32_bf16 v[224:227], v[56:59], v[152:155], v[224:227]
  buffer_load_dwordx4 v[48:51], v11, s[16:19], s74 offen offset:2048 sc1
  ds_read_b64_tr_b16 v[102:103], v7 offset:4608
  v_mfma_f32_16x16x32_bf16 v[228:231], v[60:63], v[152:155], v[228:231]
  v_mfma_f32_16x16x32_bf16 v[232:235], v[64:67], v[152:155], v[232:235]
  v_mfma_f32_16x16x32_bf16 v[236:239], v[68:71], v[152:155], v[236:239]
  ds_read_b32 v123, v4
  s_waitcnt vmcnt(19)
  v_mfma_f32_16x16x32_bf16 v[240:243], v[56:59], v[156:159], v[240:243]
  buffer_load_dwordx4 v[52:55], v11, s[16:19], s75 offen offset:2048 sc1
  v_mfma_f32_16x16x32_bf16 v[244:247], v[60:63], v[156:159], v[244:247]
  v_mfma_f32_16x16x32_bf16 v[248:251], v[64:67], v[156:159], v[248:251]
  v_mfma_f32_16x16x32_bf16 v[252:255], v[68:71], v[156:159], v[252:255]
  s_waitcnt lgkmcnt(0)
  s_waitcnt vmcnt(19)
  v_mfma_f32_16x16x32_bf16 v[192:195], v[72:75], v[160:163], v[192:195]
  v_readfirstlane_b32 s10, v123
  s_nop 0
  s_cmp_ge_u32 s10, 4
  s_cbranch_scc0 L45o
L45:
  v_mfma_f32_16x16x32_bf16 v[196:199], v[76:79], v[160:163], v[196:199]
  buffer_load_dwordx4 v[128:131], v12, s[16:19], s70 offen offset:0 sc1
  ds_read_b64_tr_b16 v[104:105], v17 offset:8192
  v_mfma_f32_16x16x32_bf16 v[200:203], v[80:83], v[160:163], v[200:203]
  ds_read_b64_tr_b16 v[106:107], v17 offset:8704
  v_mfma_f32_16x16x32_bf16 v[204:207], v[84:87], v[160:163], v[204:207]
  ds_read_b64_tr_b16 v[108:109], v6 offset:8192
  s_waitcnt vmcnt(19)
  v_mfma_f32_16x16x32_bf16 v[208:211], v[72:75], v[164:167], v[208:211]
  buffer_load_dwordx4 v[132:135], v12, s[16:19], s71 offen offset:0 sc1
  ds_read_b64_tr_b16 v[110:111], v6 offset:8704
  v_mfma_f32_16x16x32_bf16 v[212:215], v[76:79], v[164:167], v[212:215]
  ds_read_b64_tr_b16 v[112:113], v18 offset:8192
  v_mfma_f32_16x16x32_bf16 v[216:219], v[80:83], v[164:167], v[216:219]
  ds_read_b64_tr_b16 v[114:115], v18 offset:8704
  v_mfma_f32_16x16x32_bf16 v[220:223], v[84:87], v[164:167], v[220:223]
  ds_read_b64_tr_b16 v[116:117], v7 offset:8192
  s_waitcnt vmcnt(19)
  v_mfma_f32_16x16x32_bf16 v[224:227], v[72:75], v[168:171], v[224:227]
  buffer_load_dwordx4 v[136:139], v12, s[16:19], s74 offen offset:0 sc1
  ds_read_b64_tr_b16 v[118:119], v7 offset:8704
  v_mfma_f32_16x16x32_bf16 v[228:231], v[76:79], v[168:171], v[228:231]
  v_mfma_f32_16x16x32_bf16 v[232:235], v[80:83], v[168:171], v[232:235]
  v_mfma_f32_16x16x32_bf16 v[236:239], v[84:87], v[168:171], v[236:239]
  ds_read_b32 v123, v4
  s_waitcnt vmcnt(19)
  v_mfma_f32_16x16x32_bf16 v[240:243], v[72:75], v[172:175], v[240:243]
  buffer_load_dwordx4 v[140:143], v12, s[16:19], s75 offen offset:0 sc1
  v_mfma_f32_16x16x32_bf16 v[244:247], v[76:79], v[172:175], v[244:247]
  v_mfma_f32_16x16x32_bf16 v[248:251], v[80:83], v[172:175], v[248:251]
  v_mfma_f32_16x16x32_bf16 v[252:255], v[84:87], v[172:175], v[252:255]
  s_waitcnt vmcnt(12) lgkmcnt(0)
  v_mfma_f32_16x16x32_bf16 v[192:195], v[88:91], v[176:179], v[192:195]
  v_readfirstlane_b32 s10, v123
  s_nop 0
  s_cmp_ge_u32 s10, 5
  s_cbranch_scc0 L48o
L48:
  v_subrev_u32 v17, s77, v17
  v_subrev_u32 v6, s77, v6
  v_subrev_u32 v18, s77, v18
  v_subrev_u32 v7, s77, v7
  v_mfma_f32_16x16x32_bf16 v[196:199], v[92:95], v[176:179], v[196:199]
  buffer_load_dwordx4 v[144:147], v12, s[16:19], s70 offen offset:2048 sc1
  ds_read_b64_tr_b16 v[56:57], v17 offset:0
  ds_read_b64_tr_b16 v[58:59], v17 offset:512
  v_mfma_f32_16x16x32_bf16 v[200:203], v[96:99], v[176:179], v[200:203]
  ds_read_b64_tr_b16 v[60:61], v6 offset:0
  ds_read_b64_tr_b16 v[62:63], v6 offset:512
  v_mfma_f32_16x16x32_bf16 v[204:207], v[100:103], v[176:179], v[204:207]
  ds_read_b64_tr_b16 v[64:65], v18 offset:0
  ds_read_b64_tr_b16 v[66:67], v18 offset:512
  v_mfma_f32_16x16x32_bf16 v[208:211], v[88:91], v[180:183], v[208:211]
  buffer_load_dwordx4 v[148:151], v12, s[16:19], s71 offen offset:2048 sc1
  ds_read_b64_tr_b16 v[68:69], v7 offset:0
  v_mfma_f32_16x16x32_bf16 v[212:215], v[92:95], v[180:183], v[212:215]
  ds_read_b64_tr_b16 v[70:71], v7 offset:512
  v_add_f32 v20, v20, v21
  v_mfma_f32_16x16x32_bf16 v[216:219], v[96:99], v[180:183], v[216:219]
  v_add_f32 v22, v22, v23
  v_add_f32 v20, v20, v22
  v_mfma_f32_16x16x32_bf16 v[220:223], v[100:103], v[180:183], v[220:223]
  v_cvt_pk_bf16_f32 v20, v20, v20
  v_mfma_f32_16x16x32_bf16 v[224:227], v[88:91], v[184:187], v[224:227]
  buffer_load_dwordx4 v[152:155], v12, s[16:19], s74 offen offset:2048 sc1
  v_lshlrev_b32 v20, 16, v20
  v_mul_f32 v20, 0xbfb8aa3b, v20
  v_mfma_f32_16x16x32_bf16 v[228:231], v[92:95], v[184:187], v[228:231]
  v_exp_f32 v20, v20
  s_nop 0
  v_add_f32 v20, 1.0, v20
  v_mfma_f32_16x16x32_bf16 v[232:235], v[96:99], v[184:187], v[232:235]
  v_rcp_f32 v20, v20
  s_nop 0
  v_cvt_pk_bf16_f32 v20, v20, v20
  v_mfma_f32_16x16x32_bf16 v[236:239], v[100:103], v[184:187], v[236:239]
  ds_read_b32 v123, v4
  v_lshlrev_b32 v20, 16, v20
  v_mfma_f32_16x16x32_bf16 v[240:243], v[88:91], v[188:191], v[240:243]
  buffer_load_dwordx4 v[156:159], v12, s[16:19], s75 offen offset:2048 sc1
  v_sub_f32 v21, 1.0, v20
  v_cvt_pk_bf16_f32 v21, v21, v21
  v_mfma_f32_16x16x32_bf16 v[244:247], v[92:95], v[188:191], v[244:247]
  v_lshlrev_b32 v21, 16, v21
  v_lshrrev_b32 v22, 2, v1
  v_mfma_f32_16x16x32_bf16 v[248:251], v[96:99], v[188:191], v[248:251]
  v_mul_u32_u24 v22, 192, v22
  v_mfma_f32_16x16x32_bf16 v[252:255], v[100:103], v[188:191], v[252:255]
  s_waitcnt lgkmcnt(0)
  s_waitcnt vmcnt(15)
  v_mfma_f32_16x16x32_bf16 v[192:195], v[104:107], v[24:27], v[192:195]
  v_readfirstlane_b32 s10, v123
  s_nop 0
  s_cmp_ge_u32 s10, 6
  s_cbranch_scc0 L51o
L51:
  v_mfma_f32_16x16x32_bf16 v[196:199], v[108:111], v[24:27], v[196:199]
  ds_read_b64_tr_b16 v[160:161], v17 offset:4096
  ds_read_b64_tr_b16 v[162:163], v17 offset:4608
  v_mfma_f32_16x16x32_bf16 v[200:203], v[112:115], v[24:27], v[200:203]
  ds_read_b64_tr_b16 v[164:165], v6 offset:4096
  ds_read_b64_tr_b16 v[166:167], v6 offset:4608
  v_mfma_f32_16x16x32_bf16 v[204:207], v[116:119], v[24:27], v[204:207]
  ds_read_b64_tr_b16 v[168:169], v18 offset:4096
  ds_read_b64_tr_b16 v[170:171], v18 offset:4608
  s_waitcnt vmcnt(14)
  v_mfma_f32_16x16x32_bf16 v[208:211], v[104:107], v[28:31], v[208:211]
  ds_read_b64_tr_b16 v[172:173], v7 offset:4096
  v_mfma_f32_16x16x32_bf16 v[212:215], v[108:111], v[28:31], v[212:215]
  ds_read_b64_tr_b16 v[174:175], v7 offset:4608
  v_and_b32 v13, 3, v1
  v_mfma_f32_16x16x32_bf16 v[216:219], v[112:115], v[28:31], v[216:219]
  v_lshl_add_u32 v22, v13, 3, v22
  s_lshl_b32 s11, s3, 5
  v_mfma_f32_16x16x32_bf16 v[220:223], v[116:119], v[28:31], v[220:223]
  s_add_u32 s11, s11, 81920
  s_waitcnt vmcnt(13)
  v_mfma_f32_16x16x32_bf16 v[224:227], v[104:107], v[32:35], v[224:227]
  v_add_u32 v22, s11, v22
  v_mul_u32_u24 v121, 144, v15
  v_mfma_f32_16x16x32_bf16 v[228:231], v[108:111], v[32:35], v[228:231]
  v_lshrrev_b32 v13, 4, v1
  v_lshl_add_u32 v121, v13, 3, v121
  v_mfma_f32_16x16x32_bf16 v[232:235], v[112:115], v[32:35], v[232:235]
  s_add_u32 s11, s9, 16384
  v_add_u32 v121, s11, v121
  v_mfma_f32_16x16x32_bf16 v[236:239], v[116:119], v[32:35], v[236:239]
  ds_read_b32 v123, v4
  v_lshrrev_b32 v13, 3, v1
  s_waitcnt vmcnt(12)
  v_mfma_f32_16x16x32_bf16 v[240:243], v[104:107], v[36:39], v[240:243]
  v_and_b32 v15, 7, v1
  v_mul_u32_u24 v122, 144, v13
  v_mfma_f32_16x16x32_bf16 v[244:247], v[108:111], v[36:39], v[244:247]
  v_lshl_add_u32 v122, v15, 4, v122
  v_add_u32 v122, s11, v122
  v_mfma_f32_16x16x32_bf16 v[248:251], v[112:115], v[36:39], v[248:251]
  v_lshlrev_b32 v23, 10, v13
  v_mfma_f32_16x16x32_bf16 v[252:255], v[116:119], v[36:39], v[252:255]
  s_waitcnt lgkmcnt(0)
  s_waitcnt vmcnt(11)
  v_mfma_f32_16x16x32_bf16 v[192:195], v[56:59], v[40:43], v[192:195]
  v_readfirstlane_b32 s10, v123
  s_nop 0
  s_cmp_ge_u32 s10, 7
  s_cbranch_scc0 L54o
L54:
  v_mfma_f32_16x16x32_bf16 v[196:199], v[60:63], v[40:43], v[196:199]
  ds_read_b64_tr_b16 v[72:73], v17 offset:8192
  ds_read_b64_tr_b16 v[74:75], v17 offset:8704
  v_mfma_f32_16x16x32_bf16 v[200:203], v[64:67], v[40:43], v[200:203]
  ds_read_b64_tr_b16 v[76:77], v6 offset:8192
  v_mfma_f32_16x16x32_bf16 v[204:207], v[68:71], v[40:43], v[204:207]
  ds_read_b64_tr_b16 v[78:79], v6 offset:8704
  ds_read_b64_tr_b16 v[80:81], v18 offset:8192
  s_waitcnt vmcnt(10)
  v_mfma_f32_16x16x32_bf16 v[208:211], v[56:59], v[44:47], v[208:211]
  ds_read_b64_tr_b16 v[82:83], v18 offset:8704
  v_mfma_f32_16x16x32_bf16 v[212:215], v[60:63], v[44:47], v[212:215]
  ds_read_b64_tr_b16 v[84:85], v7 offset:8192
  v_mfma_f32_16x16x32_bf16 v[216:219], v[64:67], v[44:47], v[216:219]
  ds_read_b64_tr_b16 v[86:87], v7 offset:8704
  v_lshl_add_u32 v23, v15, 4, v23
  v_mfma_f32_16x16x32_bf16 v[220:223], v[68:71], v[44:47], v[220:223]
  s_xor_b32 s11, s3, 1
  s_waitcnt vmcnt(9)
  v_mfma_f32_16x16x32_bf16 v[224:227], v[56:59], v[48:51], v[224:227]
  s_mul_i32 s11, s11, 20480
  v_mfma_f32_16x16x32_bf16 v[228:231], v[60:63], v[48:51], v[228:231]
  v_add_u32 v13, s11, v2
  s_xor_b32 s11, s3, 2
  v_mfma_f32_16x16x32_bf16 v[232:235], v[64:67], v[48:51], v[232:235]
  s_mul_i32 s11, s11, 20480
  v_mfma_f32_16x16x32_bf16 v[236:239], v[68:71], v[48:51], v[236:239]
  ds_read_b32 v123, v4
  v_add_u32 v15, s11, v2
  s_waitcnt vmcnt(8)
  v_mfma_f32_16x16x32_bf16 v[240:243], v[56:59], v[52:55], v[240:243]
  s_xor_b32 s11, s3, 3
  s_mul_i32 s11, s11, 20480
  v_mfma_f32_16x16x32_bf16 v[244:247], v[60:63], v[52:55], v[244:247]
  v_add_u32 v16, s11, v2
  v_mfma_f32_16x16x32_bf16 v[248:251], v[64:67], v[52:55], v[248:251]
  s_add_u32 s11, s73, 8192
  v_mfma_f32_16x16x32_bf16 v[252:255], v[68:71], v[52:55], v[252:255]
  s_waitcnt lgkmcnt(0)
  s_waitcnt vmcnt(7)
  v_mfma_f32_16x16x32_bf16 v[192:195], v[160:163], v[128:131], v[192:195]
  v_mfma_f32_16x16x32_bf16 v[196:199], v[164:167], v[128:131], v[196:199]
  v_mfma_f32_16x16x32_bf16 v[200:203], v[168:171], v[128:131], v[200:203]
  v_mfma_f32_16x16x32_bf16 v[204:207], v[172:175], v[128:131], v[204:207]
  s_waitcnt vmcnt(6)
  v_mfma_f32_16x16x32_bf16 v[208:211], v[160:163], v[132:135], v[208:211]
  v_mfma_f32_16x16x32_bf16 v[212:215], v[164:167], v[132:135], v[212:215]
  v_mfma_f32_16x16x32_bf16 v[216:219], v[168:171], v[132:135], v[216:219]
  v_mfma_f32_16x16x32_bf16 v[220:223], v[172:175], v[132:135], v[220:223]
  s_waitcnt vmcnt(5)
  v_mfma_f32_16x16x32_bf16 v[224:227], v[160:163], v[136:139], v[224:227]
  v_mfma_f32_16x16x32_bf16 v[228:231], v[164:167], v[136:139], v[228:231]
  v_mfma_f32_16x16x32_bf16 v[232:235], v[168:171], v[136:139], v[232:235]
  v_mfma_f32_16x16x32_bf16 v[236:239], v[172:175], v[136:139], v[236:239]
  s_waitcnt vmcnt(4)
  v_mfma_f32_16x16x32_bf16 v[240:243], v[160:163], v[140:143], v[240:243]
  v_mfma_f32_16x16x32_bf16 v[244:247], v[164:167], v[140:143], v[244:247]
  v_mfma_f32_16x16x32_bf16 v[248:251], v[168:171], v[140:143], v[248:251]
  v_mfma_f32_16x16x32_bf16 v[252:255], v[172:175], v[140:143], v[252:255]
  s_waitcnt vmcnt(0)
  v_mfma_f32_16x16x32_bf16 v[192:195], v[72:75], v[144:147], v[192:195]
  v_mfma_f32_16x16x32_bf16 v[196:199], v[76:79], v[144:147], v[196:199]
  v_mfma_f32_16x16x32_bf16 v[200:203], v[80:83], v[144:147], v[200:203]
  v_mfma_f32_16x16x32_bf16 v[204:207], v[84:87], v[144:147], v[204:207]
  v_mfma_f32_16x16x32_bf16 v[208:211], v[72:75], v[148:151], v[208:211]
  s_nop 3
  ds_write_b128 v14, v[192:195] offset:0
  v_mfma_f32_16x16x32_bf16 v[212:215], v[76:79], v[148:151], v[212:215]
  ds_write_b128 v14, v[196:199] offset:1024
  v_mfma_f32_16x16x32_bf16 v[216:219], v[80:83], v[148:151], v[216:219]
  ds_write_b128 v14, v[200:203] offset:2048
  v_mfma_f32_16x16x32_bf16 v[220:223], v[84:87], v[148:151], v[220:223]
  ds_write_b128 v14, v[204:207] offset:3072
  v_mfma_f32_16x16x32_bf16 v[224:227], v[72:75], v[152:155], v[224:227]
  ds_write_b128 v14, v[208:211] offset:4096
  v_mfma_f32_16x16x32_bf16 v[228:231], v[76:79], v[152:155], v[228:231]
  ds_write_b128 v14, v[212:215] offset:5120
  v_mfma_f32_16x16x32_bf16 v[232:235], v[80:83], v[152:155], v[232:235]
  ds_write_b128 v14, v[216:219] offset:6144
  v_mfma_f32_16x16x32_bf16 v[236:239], v[84:87], v[152:155], v[236:239]
  ds_write_b128 v14, v[220:223] offset:7168
  v_mfma_f32_16x16x32_bf16 v[240:243], v[72:75], v[156:159], v[240:243]
  ds_write_b128 v14, v[224:227] offset:8192
  v_mfma_f32_16x16x32_bf16 v[244:247], v[76:79], v[156:159], v[244:247]
  ds_write_b128 v14, v[228:231] offset:9216
  v_mfma_f32_16x16x32_bf16 v[248:251], v[80:83], v[156:159], v[248:251]
  ds_write_b128 v14, v[232:235] offset:10240
  v_mfma_f32_16x16x32_bf16 v[252:255], v[84:87], v[156:159], v[252:255]
  ds_write_b128 v14, v[236:239] offset:11264
  s_waitcnt lgkmcnt(0)
  s_barrier
  ds_read_b64_tr_b16 v[84:85], v22 offset:0
  ds_read_b64_tr_b16 v[86:87], v22 offset:3072
  ds_read_b64_tr_b16 v[88:89], v22 offset:6144
  ds_read_b64_tr_b16 v[90:91], v22 offset:9216
  ds_read_b128 v[24:27], v13 offset:8192
  ds_read_b128 v[28:31], v13 offset:9216
  ds_read_b128 v[32:35], v13 offset:10240
  ds_read_b128 v[36:39], v13 offset:11264
  ds_read_b128 v[40:43], v15 offset:4096
  ds_read_b128 v[44:47], v15 offset:5120
  ds_read_b128 v[48:51], v15 offset:6144
  ds_read_b128 v[52:55], v15 offset:7168
  ds_read_b128 v[56:59], v16 offset:0
  ds_read_b128 v[60:63], v16 offset:1024
  ds_read_b128 v[64:67], v16 offset:2048
  ds_read_b128 v[68:71], v16 offset:3072
  s_waitcnt lgkmcnt(12)
  v_lshlrev_b32 v104, 16, v84
  v_and_b32 v105, 0xffff0000, v84
  v_lshlrev_b32 v106, 16, v85
  v_and_b32 v107, 0xffff0000, v85
  v_lshlrev_b32 v108, 16, v86
  v_and_b32 v109, 0xffff0000, v86
  v_lshlrev_b32 v110, 16, v87
  v_and_b32 v111, 0xffff0000, v87
  v_lshlrev_b32 v112, 16, v88
  v_and_b32 v113, 0xffff0000, v88
  v_lshlrev_b32 v114, 16, v89
  v_and_b32 v115, 0xffff0000, v89
  v_lshlrev_b32 v116, 16, v90
  v_and_b32 v117, 0xffff0000, v90
  v_lshlrev_b32 v118, 16, v91
  v_and_b32 v119, 0xffff0000, v91
  v_pk_mul_f32 v[104:105], v[104:105], v[20:21] op_sel_hi:[1,0]
  v_pk_mul_f32 v[106:107], v[106:107], v[20:21] op_sel_hi:[1,0]
  v_pk_mul_f32 v[108:109], v[108:109], v[20:21] op_sel_hi:[1,0]
  v_pk_mul_f32 v[110:111], v[110:111], v[20:21] op_sel_hi:[1,0]
  v_pk_mul_f32 v[112:113], v[112:113], v[20:21] op_sel_hi:[1,0]
  v_pk_mul_f32 v[114:115], v[114:115], v[20:21] op_sel_hi:[1,0]
  v_pk_mul_f32 v[116:117], v[116:117], v[20:21] op_sel_hi:[1,0]
  v_pk_mul_f32 v[118:119], v[118:119], v[20:21] op_sel_hi:[1,0]
  s_waitcnt lgkmcnt(8)
  v_pk_add_f32 v[240:241], v[240:241], v[24:25]
  v_pk_add_f32 v[242:243], v[242:243], v[26:27]
  v_pk_add_f32 v[244:245], v[244:245], v[28:29]
  v_pk_add_f32 v[246:247], v[246:247], v[30:31]
  v_pk_add_f32 v[248:249], v[248:249], v[32:33]
  v_pk_add_f32 v[250:251], v[250:251], v[34:35]
  v_pk_add_f32 v[252:253], v[252:253], v[36:37]
  v_pk_add_f32 v[254:255], v[254:255], v[38:39]
  s_waitcnt lgkmcnt(4)
  v_pk_add_f32 v[240:241], v[240:241], v[40:41]
  v_pk_add_f32 v[242:243], v[242:243], v[42:43]
  v_pk_add_f32 v[244:245], v[244:245], v[44:45]
  v_pk_add_f32 v[246:247], v[246:247], v[46:47]
  v_pk_add_f32 v[248:249], v[248:249], v[48:49]
  v_pk_add_f32 v[250:251], v[250:251], v[50:51]
  v_pk_add_f32 v[252:253], v[252:253], v[52:53]
  v_pk_add_f32 v[254:255], v[254:255], v[54:55]
  s_waitcnt lgkmcnt(0)
  v_pk_add_f32 v[240:241], v[240:241], v[56:57]
  v_pk_add_f32 v[242:243], v[242:243], v[58:59]
  v_pk_add_f32 v[244:245], v[244:245], v[60:61]
  v_pk_add_f32 v[246:247], v[246:247], v[62:63]
  v_pk_add_f32 v[248:249], v[248:249], v[64:65]
  v_pk_add_f32 v[250:251], v[250:251], v[66:67]
  v_pk_add_f32 v[252:253], v[252:253], v[68:69]
  v_pk_add_f32 v[254:255], v[254:255], v[70:71]
  v_pk_fma_f32 v[104:105], v[240:241], v[20:21], v[104:105] op_sel:[0,1,0]
  v_pk_fma_f32 v[106:107], v[242:243], v[20:21], v[106:107] op_sel:[0,1,0]
  v_cvt_pk_bf16_f32 v96, v104, v105
  v_cvt_pk_bf16_f32 v97, v106, v107
  ds_write_b64 v121, v[96:97] offset:0
  v_pk_fma_f32 v[108:109], v[244:245], v[20:21], v[108:109] op_sel:[0,1,0]
  v_pk_fma_f32 v[110:111], v[246:247], v[20:21], v[110:111] op_sel:[0,1,0]
  v_cvt_pk_bf16_f32 v98, v108, v109
  v_cvt_pk_bf16_f32 v99, v110, v111
  ds_write_b64 v121, v[98:99] offset:32
  v_pk_fma_f32 v[112:113], v[248:249], v[20:21], v[112:113] op_sel:[0,1,0]
  v_pk_fma_f32 v[114:115], v[250:251], v[20:21], v[114:115] op_sel:[0,1,0]
  v_cvt_pk_bf16_f32 v100, v112, v113
  v_cvt_pk_bf16_f32 v101, v114, v115
  ds_write_b64 v121, v[100:101] offset:64
  v_pk_fma_f32 v[116:117], v[252:253], v[20:21], v[116:117] op_sel:[0,1,0]
  v_pk_fma_f32 v[118:119], v[254:255], v[20:21], v[118:119] op_sel:[0,1,0]
  v_cvt_pk_bf16_f32 v102, v116, v117
  v_cvt_pk_bf16_f32 v103, v118, v119
  ds_write_b64 v121, v[102:103] offset:96
  ds_read_b128 v[24:27], v122
  ds_read_b128 v[28:31], v122 offset:1152
  s_waitcnt lgkmcnt(1)
  buffer_store_dwordx4 v[24:27], v23, s[4:7], s73 offen sc0 sc1
  s_waitcnt lgkmcnt(0)
  buffer_store_dwordx4 v[28:31], v23, s[4:7], s11 offen sc0 sc1
  s_endpgm
P2_SLOW:
  s_cmp_eq_u32 s3, 0
  s_cbranch_scc0 P2_W
  s_mov_b32 s76, 0x40000
P2_POLL:
  v_mov_b32 v15, 0
  s_mov_b64 exec, 1
  buffer_atomic_add v15, v13, s[16:19], s8 offen sc0 sc1
  s_mov_b64 exec, -1
  s_sleep 4
  s_waitcnt vmcnt(0)
  v_readfirstlane_b32 s11, v15
  s_nop 0
  s_and_b32 s10, s11, 0xffff
  s_cmp_ge_u32 s10, 14
  s_cbranch_scc1 P2_GOT
  s_sub_u32 s76, s76, 1
  s_cbranch_scc0 P2_POLL
P2_GOT:
  v_mov_b32 v5, 1
  ds_write_b32 v19, v5
  s_branch P2_GO
P2_W:
  s_mov_b32 s76, 0x40000
L32:
  ds_read_b32 v5, v19
  s_waitcnt lgkmcnt(0)
  v_readfirstlane_b32 s10, v5
  s_nop 0
  s_cmp_ge_u32 s10, 1
  s_cbranch_scc1 L33
  s_sleep 1
  s_sub_u32 s76, s76, 1
  s_cbranch_scc0 L32
L33:
  s_branch P2_GO
P2_B0:
  s_mov_b32 s76, 0x40000
P2_POLL2:
  v_readfirstlane_b32 s11, v15
  s_nop 0
  s_cmp_ge_u32 s11, 0xe0000
  s_cbranch_scc1 P2_GOT2
  v_mov_b32 v15, 0
  s_mov_b64 exec, 1
  buffer_atomic_add v15, v13, s[16:19], s8 offen sc0 sc1
  s_mov_b64 exec, -1
  s_waitcnt vmcnt(0)
  s_sub_u32 s76, s76, 1
  s_cbranch_scc0 P2_POLL2
P2_GOT2:
  v_mov_b32 v5, 2
  ds_write_b32 v19, v5
  s_branch P2_B0R
P2_B1:
  s_mov_b32 s76, 0x40000
L34:
  ds_read_b32 v5, v19
  s_waitcnt lgkmcnt(0)
  v_readfirstlane_b32 s10, v5
  s_nop 0
  s_cmp_ge_u32 s10, 2
  s_cbranch_scc1 L35
  s_sleep 1
  s_sub_u32 s76, s76, 1
  s_cbranch_scc0 L34
L35:
  s_branch P2_B1R
L36o:
  s_mov_b32 s76, 0x40000
L37:
  ds_read_b32 v123, v4
  s_waitcnt lgkmcnt(0)
  v_readfirstlane_b32 s10, v123
  s_nop 0
  s_cmp_ge_u32 s10, 1
  s_cbranch_scc1 L38
  s_sleep 1
  s_sub_u32 s76, s76, 1
  s_cbranch_scc0 L37
L38:
  s_branch L36
L39o:
  s_mov_b32 s76, 0x40000
L40:
  ds_read_b32 v123, v4
  s_waitcnt lgkmcnt(0)
  v_readfirstlane_b32 s10, v123
  s_nop 0
  s_cmp_ge_u32 s10, 2
  s_cbranch_scc1 L41
  s_sleep 1
  s_sub_u32 s76, s76, 1
  s_cbranch_scc0 L40
L41:
  s_branch L39
L42o:
  s_mov_b32 s76, 0x40000
L43:
  ds_read_b32 v123, v4
  s_waitcnt lgkmcnt(0)
  v_readfirstlane_b32 s10, v123
  s_nop 0
  s_cmp_ge_u32 s10, 3
  s_cbranch_scc1 L44
  s_sleep 1
  s_sub_u32 s76, s76, 1
  s_cbranch_scc0 L43
L44:
  s_branch L42
L45o:
  s_mov_b32 s76, 0x40000
L46:
  ds_read_b32 v123, v4
  s_waitcnt lgkmcnt(0)
  v_readfirstlane_b32 s10, v123
  s_nop 0
  s_cmp_ge_u32 s10, 4
  s_cbranch_scc1 L47
  s_sleep 1
  s_sub_u32 s76, s76, 1
  s_cbranch_scc0 L46
L47:
  s_branch L45
L48o:
  s_mov_b32 s76, 0x40000
L49:
  ds_read_b32 v123, v4
  s_waitcnt lgkmcnt(0)
  v_readfirstlane_b32 s10, v123
  s_nop 0
  s_cmp_ge_u32 s10, 5
  s_cbranch_scc1 L50
  s_sleep 1
  s_sub_u32 s76, s76, 1
  s_cbranch_scc0 L49
L50:
  s_branch L48
L51o:
  s_mov_b32 s76, 0x40000
L52:
  ds_read_b32 v123, v4
  s_waitcnt lgkmcnt(0)
  v_readfirstlane_b32 s10, v123
  s_nop 0
  s_cmp_ge_u32 s10, 6
  s_cbranch_scc1 L53
  s_sleep 1
  s_sub_u32 s76, s76, 1
  s_cbranch_scc0 L52
L53:
  s_branch L51
L54o:
  s_mov_b32 s76, 0x40000
L55:
  ds_read_b32 v123, v4
  s_waitcnt lgkmcnt(0)
  v_readfirstlane_b32 s10, v123
  s_nop 0
  s_cmp_ge_u32 s10, 7
  s_cbranch_scc1 L56
  s_sleep 1
  s_sub_u32 s76, s76, 1
  s_cbranch_scc0 L55
L56:
  s_branch L54
K_PREP:
  s_mov_b32 s25, s2
  s_mov_b32 s4, s32
  s_mov_b32 s5, s33
  s_mov_b32 s6, 0x200000
  s_mov_b32 s7, 0x20000
  s_mul_i32 s15, s3, 20480
  v_lshrrev_b32 v6, 3, v1
  v_and_b32 v5, 7, v1
  v_lshrrev_b32 v2, 4, v1
  v_lshlrev_b32 v2, 10, v2
  v_and_b32 v3, 15, v1
  v_lshl_add_u32 v2, v3, 4, v2
  s_lshl_b32 s28, s25, 16
  s_lshl_b32 s29, s3, 8
  s_add_u32 s28, s28, s29
  s_add_u32 m0, s15, 0
  s_add_u32 s29, s28, 0
  buffer_load_dwordx4 v2, s[4:7], s29 offen lds
  s_add_u32 m0, s15, 1024
  s_add_u32 s29, s28, 4096
  buffer_load_dwordx4 v2, s[4:7], s29 offen lds
  v_xor_b32 v3, 32, v2
  s_add_u32 m0, s15, 2048
  s_add_u32 s29, s28, 8192
  buffer_load_dwordx4 v3, s[4:7], s29 offen lds
  s_add_u32 m0, s15, 3072
  s_add_u32 s29, s28, 12288
  buffer_load_dwordx4 v3, s[4:7], s29 offen lds
  v_xor_b32 v3, 64, v2
  s_add_u32 m0, s15, 4096
  s_add_u32 s29, s28, 16384
  buffer_load_dwordx4 v3, s[4:7], s29 offen lds
  s_add_u32 m0, s15, 5120
  s_add_u32 s29, s28, 20480
  buffer_load_dwordx4 v3, s[4:7], s29 offen lds
  v_xor_b32 v3, 96, v2
  s_add_u32 m0, s15, 6144
  s_add_u32 s29, s28, 24576
  buffer_load_dwordx4 v3, s[4:7], s29 offen lds
  s_add_u32 m0, s15, 7168
  s_add_u32 s29, s28, 28672
  buffer_load_dwordx4 v3, s[4:7], s29 offen lds
  v_xor_b32 v3, 128, v2
  s_add_u32 m0, s15, 8192
  s_add_u32 s29, s28, 32768
  buffer_load_dwordx4 v3, s[4:7], s29 offen lds
  s_add_u32 m0, s15, 9216
  s_add_u32 s29, s28, 36864
  buffer_load_dwordx4 v3, s[4:7], s29 offen lds
  v_xor_b32 v3, 160, v2
  s_add_u32 m0, s15, 10240
  s_add_u32 s29, s28, 40960
  buffer_load_dwordx4 v3, s[4:7], s29 offen lds
  s_add_u32 m0, s15, 11264
  s_add_u32 s29, s28, 45056
  buffer_load_dwordx4 v3, s[4:7], s29 offen lds
  v_xor_b32 v3, 192, v2
  s_add_u32 m0, s15, 12288
  s_add_u32 s29, s28, 49152
  buffer_load_dwordx4 v3, s[4:7], s29 offen lds
  s_add_u32 m0, s15, 13312
  s_add_u32 s29, s28, 53248
  buffer_load_dwordx4 v3, s[4:7], s29 offen lds
  v_xor_b32 v3, 224, v2
  s_add_u32 m0, s15, 14336
  s_add_u32 s29, s28, 57344
  buffer_load_dwordx4 v3, s[4:7], s29 offen lds
  s_add_u32 m0, s15, 15360
  s_add_u32 s29, s28, 61440
  buffer_load_dwordx4 v3, s[4:7], s29 offen lds
  s_lshl_b32 s29, s3, 8
  v_lshl_add_u32 v7, v6, 4, s29
  global_load_dwordx4 v[8:11], v7, s[58:59]
  global_load_dwordx4 v[12:15], v7, s[58:59] offset:128
  v_mov_b32 v19, 0
  v_lshlrev_b32 v18, 2, v1
  s_lshl_b32 s28, s25, 8
  s_add_u32 s28, s28, 0xe10000
  buffer_store_dword v19, v18, s[16:19], s28 offen sc1
  s_mov_b32 s30, 0x05040100
  s_mov_b32 s31, 0x07060302
  v_lshlrev_b32 v16, 1, v5
  v_xor_b32 v16, v16, v6
  v_lshlrev_b32 v16, 4, v16
  v_lshl_add_u32 v16, v5, 11, v16
  v_add_u32 v16, s15, v16
  v_xor_b32 v17, 128, v16
  v_lshlrev_b32 v18, 15, v6
  v_lshl_add_u32 v18, v5, 4, v18
  v_lshl_add_u32 v19, v5, 3, v6
  v_lshlrev_b32 v19, 2, v19
  s_lshl_b32 s28, s25, 7
  s_lshl_b32 s29, s3, 19
  s_add_u32 s28, s28, s29
  s_add_u32 s28, s28, 0x900000
  s_barrier
  s_waitcnt vmcnt(1)
  ds_read_b128 v[32:35], v16 offset:0
  ds_read_b128 v[36:39], v16 offset:256
  ds_read_b128 v[40:43], v16 offset:512
  ds_read_b128 v[44:47], v16 offset:768
  ds_read_b128 v[48:51], v16 offset:1024
  ds_read_b128 v[52:55], v16 offset:1280
  ds_read_b128 v[56:59], v16 offset:1536
  ds_read_b128 v[60:63], v16 offset:1792
  ds_read_b128 v[64:67], v17 offset:0
  ds_read_b128 v[68:71], v17 offset:256
  ds_read_b128 v[72:75], v17 offset:512
  ds_read_b128 v[76:79], v17 offset:768
  ds_read_b128 v[80:83], v17 offset:1024
  ds_read_b128 v[84:87], v17 offset:1280
  ds_read_b128 v[88:91], v17 offset:1536
  ds_read_b128 v[92:95], v17 offset:1792
  s_waitcnt lgkmcnt(8)
  v_perm_b32 v96, v36, v32, s30
  v_perm_b32 v97, v44, v40, s30
  v_perm_b32 v98, v52, v48, s30
  v_perm_b32 v99, v60, v56, s30
  s_add_u32 s29, s28, 0
  buffer_store_dwordx4 v[96:99], v18, s[16:19], s29 offen sc1
  v_perm_b32 v100, v36, v32, s31
  v_perm_b32 v101, v44, v40, s31
  v_perm_b32 v102, v52, v48, s31
  v_perm_b32 v103, v60, v56, s31
  s_add_u32 s29, s28, 4096
  buffer_store_dwordx4 v[100:103], v18, s[16:19], s29 offen sc1
  v_perm_b32 v104, v37, v33, s30
  v_perm_b32 v105, v45, v41, s30
  v_perm_b32 v106, v53, v49, s30
  v_perm_b32 v107, v61, v57, s30
  s_add_u32 s29, s28, 8192
  buffer_store_dwordx4 v[104:107], v18, s[16:19], s29 offen sc1
  v_perm_b32 v108, v37, v33, s31
  v_perm_b32 v109, v45, v41, s31
  v_perm_b32 v110, v53, v49, s31
  v_perm_b32 v111, v61, v57, s31
  s_add_u32 s29, s28, 12288
  buffer_store_dwordx4 v[108:111], v18, s[16:19], s29 offen sc1
  v_perm_b32 v112, v38, v34, s30
  v_perm_b32 v113, v46, v42, s30
  v_perm_b32 v114, v54, v50, s30
  v_perm_b32 v115, v62, v58, s30
  s_add_u32 s29, s28, 16384
  buffer_store_dwordx4 v[112:115], v18, s[16:19], s29 offen sc1
  v_perm_b32 v116, v38, v34, s31
  v_perm_b32 v117, v46, v42, s31
  v_perm_b32 v118, v54, v50, s31
  v_perm_b32 v119, v62, v58, s31
  s_add_u32 s29, s28, 20480
  buffer_store_dwordx4 v[116:119], v18, s[16:19], s29 offen sc1
  v_perm_b32 v120, v39, v35, s30
  v_perm_b32 v121, v47, v43, s30
  v_perm_b32 v122, v55, v51, s30
  v_perm_b32 v123, v63, v59, s30
  s_add_u32 s29, s28, 24576
  buffer_store_dwordx4 v[120:123], v18, s[16:19], s29 offen sc1
  v_perm_b32 v124, v39, v35, s31
  v_perm_b32 v125, v47, v43, s31
  v_perm_b32 v126, v55, v51, s31
  v_perm_b32 v127, v63, v59, s31
  s_add_u32 s29, s28, 28672
  buffer_store_dwordx4 v[124:127], v18, s[16:19], s29 offen sc1
  s_waitcnt lgkmcnt(0)
  v_perm_b32 v128, v68, v64, s30
  v_perm_b32 v129, v76, v72, s30
  v_perm_b32 v130, v84, v80, s30
  v_perm_b32 v131, v92, v88, s30
  s_add_u32 s29, s28, 262144
  buffer_store_dwordx4 v[128:131], v18, s[16:19], s29 offen sc1
  v_perm_b32 v132, v68, v64, s31
  v_perm_b32 v133, v76, v72, s31
  v_perm_b32 v134, v84, v80, s31
  v_perm_b32 v135, v92, v88, s31
  s_add_u32 s29, s28, 266240
  buffer_store_dwordx4 v[132:135], v18, s[16:19], s29 offen sc1
  v_perm_b32 v136, v69, v65, s30
  v_perm_b32 v137, v77, v73, s30
  v_perm_b32 v138, v85, v81, s30
  v_perm_b32 v139, v93, v89, s30
  s_add_u32 s29, s28, 270336
  buffer_store_dwordx4 v[136:139], v18, s[16:19], s29 offen sc1
  v_perm_b32 v140, v69, v65, s31
  v_perm_b32 v141, v77, v73, s31
  v_perm_b32 v142, v85, v81, s31
  v_perm_b32 v143, v93, v89, s31
  s_add_u32 s29, s28, 274432
  buffer_store_dwordx4 v[140:143], v18, s[16:19], s29 offen sc1
  v_perm_b32 v144, v70, v66, s30
  v_perm_b32 v145, v78, v74, s30
  v_perm_b32 v146, v86, v82, s30
  v_perm_b32 v147, v94, v90, s30
  s_add_u32 s29, s28, 278528
  buffer_store_dwordx4 v[144:147], v18, s[16:19], s29 offen sc1
  v_perm_b32 v148, v70, v66, s31
  v_perm_b32 v149, v78, v74, s31
  v_perm_b32 v150, v86, v82, s31
  v_perm_b32 v151, v94, v90, s31
  s_add_u32 s29, s28, 282624
  buffer_store_dwordx4 v[148:151], v18, s[16:19], s29 offen sc1
  v_perm_b32 v152, v71, v67, s30
  v_perm_b32 v153, v79, v75, s30
  v_perm_b32 v154, v87, v83, s30
  v_perm_b32 v155, v95, v91, s30
  s_add_u32 s29, s28, 286720
  buffer_store_dwordx4 v[152:155], v18, s[16:19], s29 offen sc1
  v_perm_b32 v156, v71, v67, s31
  v_perm_b32 v157, v79, v75, s31
  v_perm_b32 v158, v87, v83, s31
  v_perm_b32 v159, v95, v91, s31
  s_add_u32 s29, s28, 290816
  buffer_store_dwordx4 v[156:159], v18, s[16:19], s29 offen sc1
  v_mov_b32 v160, 0
  v_mov_b32 v161, 0
  v_mov_b32 v162, 0
  v_mov_b32 v163, 0
  v_mov_b32 v164, 0
  v_mov_b32 v165, 0
  v_mov_b32 v166, 0
  v_mov_b32 v167, 0
  v_dot2c_f32_bf16 v160, v32, v8
  v_dot2c_f32_bf16 v161, v36, v8
  v_dot2c_f32_bf16 v162, v40, v8
  v_dot2c_f32_bf16 v163, v44, v8
  v_dot2c_f32_bf16 v164, v48, v8
  v_dot2c_f32_bf16 v165, v52, v8
  v_dot2c_f32_bf16 v166, v56, v8
  v_dot2c_f32_bf16 v167, v60, v8
  v_dot2c_f32_bf16 v160, v33, v9
  v_dot2c_f32_bf16 v161, v37, v9
  v_dot2c_f32_bf16 v162, v41, v9
  v_dot2c_f32_bf16 v163, v45, v9
  v_dot2c_f32_bf16 v164, v49, v9
  v_dot2c_f32_bf16 v165, v53, v9
  v_dot2c_f32_bf16 v166, v57, v9
  v_dot2c_f32_bf16 v167, v61, v9
  v_dot2c_f32_bf16 v160, v34, v10
  v_dot2c_f32_bf16 v161, v38, v10
  v_dot2c_f32_bf16 v162, v42, v10
  v_dot2c_f32_bf16 v163, v46, v10
  v_dot2c_f32_bf16 v164, v50, v10
  v_dot2c_f32_bf16 v165, v54, v10
  v_dot2c_f32_bf16 v166, v58, v10
  v_dot2c_f32_bf16 v167, v62, v10
  v_dot2c_f32_bf16 v160, v35, v11
  v_dot2c_f32_bf16 v161, v39, v11
  v_dot2c_f32_bf16 v162, v43, v11
  v_dot2c_f32_bf16 v163, v47, v11
  v_dot2c_f32_bf16 v164, v51, v11
  v_dot2c_f32_bf16 v165, v55, v11
  v_dot2c_f32_bf16 v166, v59, v11
  v_dot2c_f32_bf16 v167, v63, v11
  v_dot2c_f32_bf16 v160, v64, v12
  v_dot2c_f32_bf16 v161, v68, v12
  v_dot2c_f32_bf16 v162, v72, v12
  v_dot2c_f32_bf16 v163, v76, v12
  v_dot2c_f32_bf16 v164, v80, v12
  v_dot2c_f32_bf16 v165, v84, v12
  v_dot2c_f32_bf16 v166, v88, v12
  v_dot2c_f32_bf16 v167, v92, v12
  v_dot2c_f32_bf16 v160, v65, v13
  v_dot2c_f32_bf16 v161, v69, v13
  v_dot2c_f32_bf16 v162, v73, v13
  v_dot2c_f32_bf16 v163, v77, v13
  v_dot2c_f32_bf16 v164, v81, v13
  v_dot2c_f32_bf16 v165, v85, v13
  v_dot2c_f32_bf16 v166, v89, v13
  v_dot2c_f32_bf16 v167, v93, v13
  v_dot2c_f32_bf16 v160, v66, v14
  v_dot2c_f32_bf16 v161, v70, v14
  v_dot2c_f32_bf16 v162, v74, v14
  v_dot2c_f32_bf16 v163, v78, v14
  v_dot2c_f32_bf16 v164, v82, v14
  v_dot2c_f32_bf16 v165, v86, v14
  v_dot2c_f32_bf16 v166, v90, v14
  v_dot2c_f32_bf16 v167, v94, v14
  v_dot2c_f32_bf16 v160, v67, v15
  v_dot2c_f32_bf16 v161, v71, v15
  v_dot2c_f32_bf16 v162, v75, v15
  v_dot2c_f32_bf16 v163, v79, v15
  v_dot2c_f32_bf16 v164, v83, v15
  v_dot2c_f32_bf16 v165, v87, v15
  v_dot2c_f32_bf16 v166, v91, v15
  v_dot2c_f32_bf16 v167, v95, v15
  s_nop 2
  v_permlane32_swap_b32 v160, v164
  v_permlane32_swap_b32 v161, v165
  v_permlane32_swap_b32 v162, v166
  v_permlane32_swap_b32 v163, v167
  v_add_f32 v160, v160, v164
  v_add_f32 v161, v161, v165
  v_add_f32 v162, v162, v166
  v_add_f32 v163, v163, v167
  s_nop 0
  v_permlane16_swap_b32 v160, v162
  v_permlane16_swap_b32 v161, v163
  v_add_f32 v160, v160, v162
  v_add_f32 v161, v161, v163
  s_nop 0
  v_add_f32_dpp v160, v160, v160 row_ror:8 row_mask:0xf bank_mask:0xf
  v_add_f32_dpp v161, v161, v161 row_ror:8 row_mask:0xf bank_mask:0xf
  v_and_b32 v4, 8, v1
  v_cmp_ne_u32 vcc, 0, v4
  s_nop 1
  v_cndmask_b32 v160, v160, v161, vcc
  s_lshl_b32 s28, s25, 8
  s_lshl_b32 s29, s3, 13
  s_add_u32 s28, s28, s29
  s_add_u32 s28, s28, 0xe00000
  buffer_store_dword v160, v19, s[16:19], s28 offen sc1
  v_mov_b32 v3, 1
  v_mov_b32 v2, 0
  s_waitcnt vmcnt(0)
  s_mov_b64 exec, 1
  global_atomic_add v3, v2, v3, s[62:63] offset:4 sc0 sc1
  s_mov_b64 exec, -1
  s_waitcnt vmcnt(0)
  v_readfirstlane_b32 s29, v3
  s_nop 0
  s_and_b32 s28, s29, 0xffff
  s_cmp_eq_u32 s28, 127
  s_cbranch_scc0 L57
  s_mov_b64 exec, 1
  s_mov_b32 s76, 0x40000
L58:
  s_cmp_ge_u32 s29, 0
  s_cbranch_scc1 L59
  v_mov_b32 v3, 0
  global_atomic_add v3, v2, v3, s[62:63] offset:4 sc0 sc1
  s_waitcnt vmcnt(0)
  v_readfirstlane_b32 s29, v3
  s_sub_u32 s76, s76, 1
  s_cbranch_scc0 L58
L59:
  v_mov_b32 v3, 32
  global_store_dword v2, v3, s[62:63] offset:132 sc1
  s_mov_b64 exec, -1
L57:
  v_mov_b32 v20, -1
  v_mov_b32 v21, -1
  v_mov_b32 v22, -1
  v_mov_b32 v23, -1
  v_lshlrev_b32 v24, 4, v1
  s_lshl_b32 s28, s25, 16
  s_lshl_b32 s29, s3, 14
  s_add_u32 s28, s28, s29
  s_add_u32 s28, s28, 0xb00000
  buffer_store_dwordx4 v[20:23], v24, s[16:19], s28 offen offset:0 sc1
  buffer_store_dwordx4 v[20:23], v24, s[16:19], s28 offen offset:1024 sc1
  buffer_store_dwordx4 v[20:23], v24, s[16:19], s28 offen offset:2048 sc1
  buffer_store_dwordx4 v[20:23], v24, s[16:19], s28 offen offset:3072 sc1
  s_add_u32 s28, s28, 4096
  buffer_store_dwordx4 v[20:23], v24, s[16:19], s28 offen offset:0 sc1
  buffer_store_dwordx4 v[20:23], v24, s[16:19], s28 offen offset:1024 sc1
  buffer_store_dwordx4 v[20:23], v24, s[16:19], s28 offen offset:2048 sc1
  buffer_store_dwordx4 v[20:23], v24, s[16:19], s28 offen offset:3072 sc1
  s_add_u32 s28, s28, 4096
  buffer_store_dwordx4 v[20:23], v24, s[16:19], s28 offen offset:0 sc1
  buffer_store_dwordx4 v[20:23], v24, s[16:19], s28 offen offset:1024 sc1
  buffer_store_dwordx4 v[20:23], v24, s[16:19], s28 offen offset:2048 sc1
  buffer_store_dwordx4 v[20:23], v24, s[16:19], s28 offen offset:3072 sc1
  s_add_u32 s28, s28, 4096
  buffer_store_dwordx4 v[20:23], v24, s[16:19], s28 offen offset:0 sc1
  buffer_store_dwordx4 v[20:23], v24, s[16:19], s28 offen offset:1024 sc1
  buffer_store_dwordx4 v[20:23], v24, s[16:19], s28 offen offset:2048 sc1
  buffer_store_dwordx4 v[20:23], v24, s[16:19], s28 offen offset:3072 sc1
  s_mov_b32 s20, s56
  s_mov_b32 s21, s57
  s_mov_b32 s22, 0x1c0000
  s_mov_b32 s23, 0x20000
  v_lshlrev_b32 v2, 4, v1
  s_mul_i32 s69, s3, 458752
  s_lshl_b32 s12, s68, 7
  s_add_u32 s69, s69, s12
  s_mul_i32 s12, s3, 28672
  s_mul_i32 s10, s67, 229376
  s_add_u32 s10, s10, s12
  s_xor_b32 s11, s3, 3
  s_lshr_b32 s70, s11, 1
  s_mul_i32 s70, s70, 114688
  s_and_b32 s11, s11, 1
  s_lshl_b32 s11, s11, 8
  s_add_u32 s70, s70, s11
  s_add_u32 s70, s70, s10
  s_xor_b32 s11, s3, 2
  s_lshr_b32 s71, s11, 1
  s_mul_i32 s71, s71, 114688
  s_and_b32 s11, s11, 1
  s_lshl_b32 s11, s11, 8
  s_add_u32 s71, s71, s11
  s_add_u32 s71, s71, s10
  s_xor_b32 s11, s3, 1
  s_lshr_b32 s74, s11, 1
  s_mul_i32 s74, s74, 114688
  s_and_b32 s11, s11, 1
  s_lshl_b32 s11, s11, 8
  s_add_u32 s74, s74, s11
  s_add_u32 s74, s74, s10
  s_xor_b32 s11, s3, 0
  s_lshr_b32 s75, s11, 1
  s_mul_i32 s75, s75, 114688
  s_and_b32 s11, s11, 1
  s_lshl_b32 s11, s11, 8
  s_add_u32 s75, s75, s11
  s_add_u32 s75, s75, s10
  s_and_b32 s12, s3, 1
  s_lshr_b32 s13, s3, 1
  s_mul_i32 s9, s3, 20480
  s_mov_b32 s4, s60
  s_mov_b32 s5, s61
  s_mov_b32 s6, 0x200000
  s_mov_b32 s7, 0x20000
  s_lshl_b32 s14, s67, 6
  s_lshl_b32 s15, s3, 4
  s_add_u32 s14, s14, s15
  s_lshl_b32 s15, s14, 2
  s_add_u32 s15, s15, 0xe00000
  s_lshl_b32 s73, s14, 10
  s_lshl_b32 s10, s68, 7
  s_add_u32 s73, s73, s10
  v_lshrrev_b32 v4, 4, v1
  v_and_b32 v5, 15, v1
  v_lshlrev_b32 v5, 4, v5
  v_lshl_add_u32 v120, v4, 9, v5
  v_add_u32 v3, 4096, v120
  v_add_u32 v8, 8192, v120
  v_add_u32 v9, 12288, v120
  v_add_u32 v10, 16384, v120
  v_add_u32 v11, 20480, v120
  v_add_u32 v12, 24576, v120
  v_bfe_u32 v4, v1, 4, 1
  v_lshlrev_b32 v16, 2, v4
  v_and_b32 v5, 7, v1
  v_xor_b32 v16, v16, v5
  v_lshlrev_b32 v16, 4, v16
  v_lshrrev_b32 v5, 3, v1
  v_lshl_add_u32 v16, v5, 10, v16
  v_xor_b32 v126, 32, v16
  v_lshrrev_b32 v4, 5, v1
  v_lshlrev_b32 v17, 11, v4
  v_bfe_u32 v4, v1, 4, 1
  v_bfe_u32 v5, v1, 2, 2
  v_lshl_add_u32 v4, v4, 3, v5
  v_lshl_add_u32 v17, v4, 7, v17
  v_and_b32 v4, 3, v1
  v_lshl_add_u32 v17, v4, 3, v17
  v_lshrrev_b32 v5, 1, v5
  v_lshl_add_u32 v17, v5, 6, v17
  v_bfe_u32 v4, v1, 4, 1
  v_lshl_add_u32 v17, v4, 5, v17
  v_add_u32 v17, s9, v17
  v_xor_b32 v18, 64, v17
  v_add_u32 v14, s9, v2
  s_lshr_b32 s10, s67, 1
  s_lshl_b32 s10, s10, 8
  s_add_u32 s8, s10, 0xe10000
  s_cmp_eq_u32 s3, 0
  s_cselect_b32 s10, 0, 0x2000000
  v_mov_b32 v13, s10
  v_mov_b32 v15, 0
  s_add_u32 m0, s9, 8192
  s_add_u32 s10, s69, 0
  buffer_load_dwordx4 v16, s[20:23], s10 offen lds
  s_add_u32 m0, s9, 9216
  s_add_u32 s10, s69, 8192
  buffer_load_dwordx4 v126, s[20:23], s10 offen lds
  s_add_u32 m0, s9, 10240
  s_add_u32 s10, s69, 32768
  buffer_load_dwordx4 v16, s[20:23], s10 offen lds
  s_add_u32 m0, s9, 11264
  s_add_u32 s10, s69, 40960
  buffer_load_dwordx4 v126, s[20:23], s10 offen lds
  s_add_u32 m0, s9, 12288
  s_add_u32 s10, s69, 65536
  buffer_load_dwordx4 v16, s[20:23], s10 offen lds
  s_add_u32 m0, s9, 13312
  s_add_u32 s10, s69, 73728
  buffer_load_dwordx4 v126, s[20:23], s10 offen lds
  s_add_u32 m0, s9, 14336
  s_add_u32 s10, s69, 98304
  buffer_load_dwordx4 v16, s[20:23], s10 offen lds
  s_add_u32 m0, s9, 15360
  s_add_u32 s10, s69, 106496
  buffer_load_dwordx4 v126, s[20:23], s10 offen lds
  s_add_u32 m0, s9, 16384
  s_add_u32 s10, s69, 131072
  buffer_load_dwordx4 v16, s[20:23], s10 offen lds
  s_add_u32 m0, s9, 17408
  s_add_u32 s10, s69, 139264
  buffer_load_dwordx4 v126, s[20:23], s10 offen lds
  s_add_u32 m0, s9, 18432
  s_add_u32 s10, s69, 163840
  buffer_load_dwordx4 v16, s[20:23], s10 offen lds
  s_add_u32 m0, s9, 19456
  s_add_u32 s10, s69, 172032
  buffer_load_dwordx4 v126, s[20:23], s10 offen lds
  s_waitcnt vmcnt(0)
  v_mov_b32 v122, 1
  v_mov_b32 v121, 0
  s_waitcnt vmcnt(0)
  s_mov_b64 exec, 1
  global_atomic_add v122, v121, v122, s[62:63] offset:0 sc0 sc1
  s_mov_b64 exec, -1
  s_waitcnt vmcnt(0)
  v_readfirstlane_b32 s29, v122
  s_nop 0
  s_and_b32 s28, s29, 0xffff
  s_cmp_eq_u32 s28, 127
  s_cbranch_scc0 L60
  s_mov_b64 exec, 1
  s_mov_b32 s76, 0x40000
L61:
  s_cmp_ge_u32 s29, 0
  s_cbranch_scc1 L62
  v_mov_b32 v122, 0
  global_atomic_add v122, v121, v122, s[62:63] offset:0 sc0 sc1
  s_waitcnt vmcnt(0)
  v_readfirstlane_b32 s29, v122
  s_sub_u32 s76, s76, 1
  s_cbranch_scc0 L61
L62:
  v_mov_b32 v122, 32
  global_store_dword v121, v122, s[62:63] offset:128 sc1
  s_mov_b64 exec, -1
L60:
  v_xor_b32 v6, 32, v17
  v_xor_b32 v7, 32, v18
  ds_read_b64_tr_b16 v[72:73], v17 offset:8192
  ds_read_b64_tr_b16 v[74:75], v17 offset:8704
  ds_read_b64_tr_b16 v[76:77], v6 offset:8192
  ds_read_b64_tr_b16 v[78:79], v6 offset:8704
  ds_read_b64_tr_b16 v[80:81], v18 offset:8192
  ds_read_b64_tr_b16 v[82:83], v18 offset:8704
  ds_read_b64_tr_b16 v[84:85], v7 offset:8192
  ds_read_b64_tr_b16 v[86:87], v7 offset:8704
  ds_read_b64_tr_b16 v[88:89], v17 offset:12288
  ds_read_b64_tr_b16 v[90:91], v17 offset:12800
  ds_read_b64_tr_b16 v[92:93], v6 offset:12288
  ds_read_b64_tr_b16 v[94:95], v6 offset:12800
  ds_read_b64_tr_b16 v[96:97], v18 offset:12288
  ds_read_b64_tr_b16 v[98:99], v18 offset:12800
  ds_read_b64_tr_b16 v[100:101], v7 offset:12288
  ds_read_b64_tr_b16 v[102:103], v7 offset:12800
  ds_read_b64_tr_b16 v[104:105], v17 offset:16384
  ds_read_b64_tr_b16 v[106:107], v17 offset:16896
  ds_read_b64_tr_b16 v[108:109], v6 offset:16384
  ds_read_b64_tr_b16 v[110:111], v6 offset:16896
  ds_read_b64_tr_b16 v[112:113], v18 offset:16384
  ds_read_b64_tr_b16 v[114:115], v18 offset:16896
  ds_read_b64_tr_b16 v[116:117], v7 offset:16384
  ds_read_b64_tr_b16 v[118:119], v7 offset:16896
  s_waitcnt lgkmcnt(0)
  v_mov_b32 v4, 163808
  v_mov_b32 v5, 1
  s_mov_b64 exec, 1
  ds_add_u32 v4, v5
  s_mov_b64 exec, -1
  v_mov_b32 v4, 163792
  s_mov_b32 s76, 0x40000
L63:
  ds_read_b32 v5, v4
  s_waitcnt lgkmcnt(0)
  v_readfirstlane_b32 s10, v5
  s_nop 0
  s_cmp_ge_u32 s10, 32
  s_cbranch_scc1 L64
  s_sleep 2
  s_sub_u32 s76, s76, 1
  s_cbranch_scc0 L63
L64:
  s_mov_b32 s10, 0
  s_waitcnt vmcnt(0)
  s_branch P2_START
K_END:
  s_endpgm
.section .rodata,"a"
.p2align 6
.amdhsa_kernel gated_mix__ssm_conv_s4__glu_gated_glu__prompt_kernel
  .amdhsa_next_free_vgpr 256
  .amdhsa_next_free_sgpr 102
  .amdhsa_accum_offset 256
  .amdhsa_group_segment_fixed_size 0
  .amdhsa_kernarg_size 136
  .amdhsa_user_sgpr_count 2
  .amdhsa_user_sgpr_kernarg_segment_ptr 1
  .amdhsa_system_sgpr_workgroup_id_x 1
.end_amdhsa_kernel
```
